```python
import torch

def _softmax(x, axis=-1):
    return torch.softmax(x, dim=axis)
def _gelu(x):
    return torch.nn.functional.gelu(x, approximate="tanh")
def _silu(x):
    return torch.nn.functional.silu(x)
def _sigmoid(x):
    return torch.sigmoid(x)
def _layernorm(x, axis=-1, eps=1e-5):
    m = x.mean(dim=axis, keepdim=True)
    v = x.var(dim=axis, keepdim=True, unbiased=False)
    return (x - m) / torch.sqrt(v + eps)
def _scatter_add(tgt, idx, src, axis=0):
    return tgt.clone().index_add_(axis, idx, src)
def _segment_sum(src, seg, n):
    out = torch.zeros((n,) + src.shape[1:], dtype=src.dtype)
    return out.index_add_(0, seg, src)
def _pad(x, pw):
    flat = tuple(v for pair in reversed(pw) for v in pair)
    return torch.nn.functional.pad(x, flat)

kernel_name = 'gated_mix__mha_block_cached__mixer_channel_mlp__decode'

def setup_inputs():

    _w = (lambda a: (lambda t: t.to(torch.bfloat16) if t.is_floating_point() else t)(torch.as_tensor(a)))
    def _A_setup():
        B, Sq, D = 2, 1, 576
        H, Sk, Dh = 32, 4096, 128
        return {
            "x": _w((lambda *s: torch.randn(*s, dtype=torch.bfloat16) * 0.05)(B, Sq, D)),
            "k_cache": _w((lambda *s: torch.randn(*s, dtype=torch.bfloat16) * 6.4)(B, H, Sk, Dh)),
            "v_cache": _w((lambda *s: torch.randn(*s, dtype=torch.bfloat16) * 1.6)(B, H, Sk, Dh)),
            "wq": _w((lambda *s: torch.randn(*s, dtype=torch.bfloat16) * 6.4)(D, H * Dh) * (D ** -0.5)),
            "wo": _w((lambda *s: torch.randn(*s, dtype=torch.bfloat16) * 1.6)(H * Dh, D) * ((H * Dh) ** -0.5)),
        }
    _A_in = _A_setup()

    def _B_setup():
        B, S, D, F = 2, 1, 576, 4608
        return {
            "x": _w((lambda *s: torch.randn(*s, dtype=torch.bfloat16) * 0.05)(B, S, D)),
            "w1": _w((lambda *s: torch.randn(*s, dtype=torch.bfloat16) * 3.2)(D, F) * (D ** -0.5)),
            "b1": _w((lambda *s: torch.randn(*s, dtype=torch.bfloat16) * 1.6)(F)),
            "w2": _w((lambda *s: torch.randn(*s, dtype=torch.bfloat16) * 0.1)(F, D) * (F ** -0.5)),
            "b2": _w((lambda *s: torch.randn(*s, dtype=torch.bfloat16) * 0.1)(D)),
        }
    _B_in = _B_setup()

    return {
        "A_x": _A_in["x"],
        "A_k_cache": _A_in["k_cache"],
        "A_v_cache": _A_in["v_cache"],
        "A_wq": _A_in["wq"],
        "A_wo": _A_in["wo"],
        "B_x": _B_in["x"],
        "B_w1": _B_in["w1"],
        "B_b1": _B_in["b1"],
        "B_w2": _B_in["w2"],
        "B_b2": _B_in["b2"],
        "gate_w": _w((lambda *s: torch.randn(*s, dtype=torch.bfloat16) * 0.05)(576) * 16.0),
    }

def reference(A_x, A_k_cache, A_v_cache, A_wq, A_wo, B_x, B_w1, B_b1, B_w2, B_b2, gate_w):
    def _A_ref(x, k_cache, v_cache, wq, wo):
        B, Sq, D = x.shape
        H, Dh = 32, 128
        q = (lambda x, *d: x.permute(*d))((x @ wq).reshape(B, Sq, H, Dh), 0, 2, 1, 3)
        scores = torch.einsum("bhqd,bhkd->bhqk", q, k_cache) * (Dh ** -0.5)
        p = _softmax(scores, axis=-1)
        o = torch.einsum("bhqk,bhkd->bhqd", p, v_cache)
        return (lambda x, *d: x.permute(*d))(o, 0, 2, 1, 3).reshape(B, Sq, H * Dh) @ wo

    def _B_ref(x, w1, b1, w2, b2):
        y = _layernorm(x, axis=-1)
        h = _gelu(torch.einsum("bsd,df->bsf", y, w1) + b1)
        return torch.einsum("bsf,fd->bsd", h, w2) + b2

    x = A_x
    g = _sigmoid((x * gate_w).sum(-1, keepdims=True))
    a = _A_ref(x, A_k_cache, A_v_cache, A_wq, A_wo)
    b = _B_ref(x, B_w1, B_b1, B_w2, B_b2)
    return g * a + (1 - g) * b
```

```asm
; @launch grid=(256,1,1) block=(768,1,1) lds=27200
.amdgcn_target "amdgcn-amd-amdhsa--gfx950"
.text
.globl gated_mix__mha_block_cached__mixer_channel_mlp__decode_kernel
.p2align 8
.type gated_mix__mha_block_cached__mixer_channel_mlp__decode_kernel,@function
gated_mix__mha_block_cached__mixer_channel_mlp__decode_kernel:
    s_cmp_ge_u32 s2, 256
    s_cbranch_scc1 L_end
    s_load_dwordx16 s[16:31], s[0:1], 0
    s_load_dwordx8 s[32:39], s[0:1], 64
    s_load_dwordx4 s[40:43], s[0:1], 96
    v_lshrrev_b32 v2, 6, v0
    v_and_b32 v1, 63, v0
    v_readfirstlane_b32 s3, v2
    s_and_b32 s9, s2, 7
    s_lshr_b32 s10, s2, 3
    s_and_b32 s4, s10, 3
    s_lshl_b32 s11, s9, 2
    s_add_u32 s4, s4, s11
    s_lshr_b32 s5, s10, 2
    s_lshl_b32 s6, s4, 3
    v_mov_b32 v3, 0
    v_lshlrev_b32 v2, 2, v1
    ds_write_b32 v2, v3 offset:0
    s_cmp_ge_u32 s3, 4
    s_cbranch_scc1 L_stream
    s_cmp_ge_u32 s2, 256
    s_cbranch_scc1 L_nopf
    s_getpc_b64 s[78:79]
    v_lshlrev_b32 v4, 7, v0
    v_min_u32 v4, L_end-L_pc, v4
L_pc:
    global_load_dword v167, v4, s[78:79]
L_nopf:
    v_lshrrev_b32 v2, 4, v1
    v_and_b32 v3, 15, v1
    v_bfe_u32 v16, v1, 3, 1
    v_lshlrev_b32 v17, 4, v3
    v_lshl_add_u32 v18, v2, 15, v17
    v_lshl_add_u32 v19, v2, 13, v17
    v_lshlrev_b32 v20, 26, v1
    v_and_b32 v20, 0x80000000, v20
    v_or_b32 v19, v19, v20
    s_lshl_b32 s9, s5, 2
    s_add_u32 s9, s9, s3
    s_mul_i32 s10, s9, 36
    v_mul_u32_u24 v20, 0x480, v16
    v_add_u32 v20, s10, v20
    v_lshl_add_u32 v21, v2, 3, v20
    s_mul_i32 s9, s9, 147456
    s_lshl_b32 s10, s4, 8
    s_add_u32 s9, s9, s10
    s_waitcnt lgkmcnt(0)
    s_mov_b32 s52, s22
    s_mov_b32 s53, s23
    s_mov_b32 s54, 0x480000
    s_mov_b32 s55, 0x20000
    global_load_dwordx2 v[50:51], v21, s[16:17]
    global_load_dword v52, v20, s[16:17] offset:32
    buffer_load_dwordx4 v[76:79], v18, s[52:55], s9 offen nt
    s_add_u32 s9, s9, 0x2000
    buffer_load_dwordx4 v[80:83], v18, s[52:55], s9 offen nt
    s_add_u32 s9, s9, 0x2000
    buffer_load_dwordx4 v[84:87], v18, s[52:55], s9 offen nt
    s_add_u32 s9, s9, 0x2000
    buffer_load_dwordx4 v[88:91], v18, s[52:55], s9 offen nt
    s_add_u32 s9, s9, 0x1a000
    buffer_load_dwordx4 v[92:95], v19, s[52:55], s9 offen nt
    s_barrier
    s_branch L_helper
L_stream:
    s_sub_u32 s14, s3, 4
    s_lshl_b32 s8, s4, 20
    s_lshl_b32 s11, s5, 17
    s_add_u32 s8, s8, s11
    s_lshl_b32 s11, s14, 12
    s_add_u32 s8, s8, s11
    v_lshrrev_b32 v65, 4, v1
    v_lshlrev_b32 v3, 4, v1
    v_bfe_u32 v64, v1, 2, 2
    v_lshlrev_b32 v2, 8, v64
    v_lshl_add_u32 v2, v65, 6, v2
    v_and_b32 v64, 3, v1
    v_lshl_add_u32 v2, v64, 4, v2
    s_waitcnt lgkmcnt(0)
    s_mov_b32 s44, s18
    s_mov_b32 s45, s19
    s_mov_b32 s46, 0x4000000
    s_mov_b32 s47, 0x20000
    s_add_u32 s12, s8, 0x0
    buffer_load_dwordx4 v[72:75], v2, s[44:47], s12 offen offset:0 nt
    buffer_load_dwordx4 v[76:79], v2, s[44:47], s12 offen offset:1024 nt
    buffer_load_dwordx4 v[80:83], v2, s[44:47], s12 offen offset:2048 nt
    buffer_load_dwordx4 v[84:87], v2, s[44:47], s12 offen offset:3072 nt
    s_barrier
    s_add_u32 s72, s42, 0x1e8000
    s_addc_u32 s73, s43, 0
    s_load_dwordx2 s[86:87], s[72:73], 0
    s_mov_b32 s48, s20
    s_mov_b32 s49, s21
    s_mov_b32 s50, 0x4000000
    s_mov_b32 s51, 0x20000
    s_mov_b32 s68, s42
    s_mov_b32 s69, s43
    s_mov_b32 s70, 0x1e8080
    s_mov_b32 s71, 0x20000
    s_mov_b32 s91, 0x3e0293ee
    v_lshl_add_u32 v66, v65, 2, v64
    v_lshlrev_b32 v66, 4, v66
    v_mov_b32 v67, 0
    v_and_b32 v64, 1, v1
    v_lshlrev_b32 v64, 4, v64
    v_mov_b32 v65, 0xffff
    v_lshlrev_b32 v64, v64, v65
    s_mov_b32 s94, 0x3030303
    s_mov_b32 s95, 0x3030303
    v_cndmask_b32 v4, 0, v64, s[94:95]
    s_mov_b32 s94, 0xc0c0c0c
    s_mov_b32 s95, 0xc0c0c0c
    v_cndmask_b32 v5, 0, v64, s[94:95]
    s_mov_b32 s94, 0x30303030
    s_mov_b32 s95, 0x30303030
    v_cndmask_b32 v6, 0, v64, s[94:95]
    s_mov_b32 s94, 0xc0c0c0c0
    s_mov_b32 s95, 0xc0c0c0c0
    v_cndmask_b32 v7, 0, v64, s[94:95]
    s_waitcnt vmcnt(0)
    s_add_u32 s12, s8, 0x8000
    buffer_load_dwordx4 v[88:91], v2, s[44:47], s12 offen offset:0 nt
    buffer_load_dwordx4 v[92:95], v2, s[44:47], s12 offen offset:1024 nt
    buffer_load_dwordx4 v[96:99], v2, s[44:47], s12 offen offset:2048 nt
    buffer_load_dwordx4 v[100:103], v2, s[44:47], s12 offen offset:3072 nt
    s_waitcnt vmcnt(0)
    s_add_u32 s12, s8, 0x10000
    buffer_load_dwordx4 v[104:107], v2, s[44:47], s12 offen offset:0 nt
    buffer_load_dwordx4 v[108:111], v2, s[44:47], s12 offen offset:1024 nt
    buffer_load_dwordx4 v[112:115], v2, s[44:47], s12 offen offset:2048 nt
    buffer_load_dwordx4 v[116:119], v2, s[44:47], s12 offen offset:3072 nt
    v_mov_b32 v64, 0
    v_mov_b32 v65, 1
    s_mov_b64 exec, 1
    ds_add_u32 v64, v65 offset:136
    s_mov_b64 exec, -1
    s_waitcnt vmcnt(0)
    s_add_u32 s12, s8, 0x18000
    buffer_load_dwordx4 v[120:123], v2, s[44:47], s12 offen offset:0 nt
    buffer_load_dwordx4 v[124:127], v2, s[44:47], s12 offen offset:1024 nt
    buffer_load_dwordx4 v[128:131], v2, s[44:47], s12 offen offset:2048 nt
    buffer_load_dwordx4 v[132:135], v2, s[44:47], s12 offen offset:3072 nt
    s_waitcnt vmcnt(0)
    s_add_u32 s12, s8, 0x2000000
    buffer_load_dwordx4 v[136:139], v2, s[44:47], s12 offen offset:0 nt
    buffer_load_dwordx4 v[140:143], v2, s[44:47], s12 offen offset:1024 nt
    buffer_load_dwordx4 v[144:147], v2, s[44:47], s12 offen offset:2048 nt
    buffer_load_dwordx4 v[148:151], v2, s[44:47], s12 offen offset:3072 nt
    s_waitcnt vmcnt(0)
    s_add_u32 s12, s8, 0x2008000
    buffer_load_dwordx4 v[152:155], v2, s[44:47], s12 offen offset:0 nt
    buffer_load_dwordx4 v[156:159], v2, s[44:47], s12 offen offset:1024 nt
    buffer_load_dwordx4 v[160:163], v2, s[44:47], s12 offen offset:2048 nt
    buffer_load_dwordx4 v[164:167], v2, s[44:47], s12 offen offset:3072 nt
    s_mov_b32 s13, 0x40000
    s_branch L_fq_go
L_fq_spin:
    s_sleep 1
L_fq_go:
    ds_read_b32 v64, v67 offset:128
    s_waitcnt lgkmcnt(0)
L_fq_chk:
    v_cmp_eq_u32 vcc, 0, v64
    s_sub_u32 s13, s13, 1
    s_cbranch_scc1 L_fq_ok
    s_cbranch_vccnz L_fq_spin
L_fq_ok:
    ds_read_b128 v[32:35], v66 offset:256
    ds_read_b128 v[36:39], v66 offset:512
    ds_read_b32 v64, v67 offset:164
    s_add_u32 s86, s86, 1
    s_add_u32 s87, s87, 0x9e3779b9
    s_and_b32 s72, s86, 0xfff
    s_and_b32 s73, s87, 0xfff
    s_bfe_u32 s74, s87, 0xc000c
    s_lshr_b32 s75, s87, 20
    s_waitcnt lgkmcnt(0)
    v_readfirstlane_b32 s82, v64
    s_mov_b32 s94, 0xf000f
    s_mov_b32 s95, 0xf000f
    v_cndmask_b32 v16, 0, v32, s[94:95]
    v_cndmask_b32 v17, 0, v33, s[94:95]
    v_cndmask_b32 v18, 0, v34, s[94:95]
    v_cndmask_b32 v19, 0, v35, s[94:95]
    s_mov_b32 s94, 0xf000f0
    s_mov_b32 s95, 0xf000f0
    v_cndmask_b32 v20, 0, v32, s[94:95]
    v_cndmask_b32 v21, 0, v33, s[94:95]
    v_cndmask_b32 v22, 0, v34, s[94:95]
    v_cndmask_b32 v23, 0, v35, s[94:95]
    s_mov_b32 s94, 0xf000f00
    s_mov_b32 s95, 0xf000f00
    v_cndmask_b32 v24, 0, v32, s[94:95]
    v_cndmask_b32 v25, 0, v33, s[94:95]
    v_cndmask_b32 v26, 0, v34, s[94:95]
    v_cndmask_b32 v27, 0, v35, s[94:95]
    s_mov_b32 s94, 0xf000f000
    s_mov_b32 s95, 0xf000f000
    v_cndmask_b32 v28, 0, v32, s[94:95]
    v_cndmask_b32 v29, 0, v33, s[94:95]
    v_cndmask_b32 v30, 0, v34, s[94:95]
    v_cndmask_b32 v31, 0, v35, s[94:95]
    v_mfma_f32_16x16x32_bf16 v[48:51], v[72:75], v[16:19], 0
    v_mfma_f32_16x16x32_bf16 v[48:51], v[76:79], v[20:23], v[48:51]
    v_mfma_f32_16x16x32_bf16 v[48:51], v[80:83], v[24:27], v[48:51]
    v_mfma_f32_16x16x32_bf16 v[48:51], v[84:87], v[28:31], v[48:51]
    v_mfma_f32_16x16x32_bf16 v[52:55], v[88:91], v[16:19], 0
    v_mfma_f32_16x16x32_bf16 v[52:55], v[92:95], v[20:23], v[52:55]
    v_mfma_f32_16x16x32_bf16 v[52:55], v[96:99], v[24:27], v[52:55]
    v_mfma_f32_16x16x32_bf16 v[52:55], v[100:103], v[28:31], v[52:55]
    s_nop 3
    v_mov_b32_dpp v40, v48 quad_perm:[0,0,0,0] row_mask:0xf bank_mask:0xf
    s_nop 1
    v_add_f32_dpp v40, v49, v40 quad_perm:[1,1,1,1] row_mask:0xf bank_mask:0xf
    s_nop 1
    v_add_f32_dpp v40, v50, v40 quad_perm:[2,2,2,2] row_mask:0xf bank_mask:0xf
    s_nop 1
    v_add_f32_dpp v40, v51, v40 quad_perm:[3,3,3,3] row_mask:0xf bank_mask:0xf
    v_mfma_f32_16x16x32_bf16 v[48:51], v[104:107], v[16:19], 0
    v_mfma_f32_16x16x32_bf16 v[48:51], v[108:111], v[20:23], v[48:51]
    v_mfma_f32_16x16x32_bf16 v[48:51], v[112:115], v[24:27], v[48:51]
    v_mfma_f32_16x16x32_bf16 v[48:51], v[116:119], v[28:31], v[48:51]
    v_mov_b32_dpp v41, v52 quad_perm:[0,0,0,0] row_mask:0xf bank_mask:0xf
    s_nop 1
    v_add_f32_dpp v41, v53, v41 quad_perm:[1,1,1,1] row_mask:0xf bank_mask:0xf
    s_nop 1
    v_add_f32_dpp v41, v54, v41 quad_perm:[2,2,2,2] row_mask:0xf bank_mask:0xf
    s_nop 1
    v_add_f32_dpp v41, v55, v41 quad_perm:[3,3,3,3] row_mask:0xf bank_mask:0xf
    s_waitcnt vmcnt(0)
    s_add_u32 s12, s8, 0x2010000
    buffer_load_dwordx4 v[72:75], v2, s[44:47], s12 offen offset:0 nt
    buffer_load_dwordx4 v[76:79], v2, s[44:47], s12 offen offset:1024 nt
    buffer_load_dwordx4 v[80:83], v2, s[44:47], s12 offen offset:2048 nt
    buffer_load_dwordx4 v[84:87], v2, s[44:47], s12 offen offset:3072 nt
    v_mfma_f32_16x16x32_bf16 v[52:55], v[120:123], v[16:19], 0
    v_mfma_f32_16x16x32_bf16 v[52:55], v[124:127], v[20:23], v[52:55]
    v_mfma_f32_16x16x32_bf16 v[52:55], v[128:131], v[24:27], v[52:55]
    v_mfma_f32_16x16x32_bf16 v[52:55], v[132:135], v[28:31], v[52:55]
    v_mov_b32_dpp v42, v48 quad_perm:[0,0,0,0] row_mask:0xf bank_mask:0xf
    s_nop 1
    v_add_f32_dpp v42, v49, v42 quad_perm:[1,1,1,1] row_mask:0xf bank_mask:0xf
    s_nop 1
    v_add_f32_dpp v42, v50, v42 quad_perm:[2,2,2,2] row_mask:0xf bank_mask:0xf
    s_nop 1
    v_add_f32_dpp v42, v51, v42 quad_perm:[3,3,3,3] row_mask:0xf bank_mask:0xf
    s_mov_b32 s94, 0xf000f
    s_mov_b32 s95, 0xf000f
    v_cndmask_b32 v16, 0, v36, s[94:95]
    v_cndmask_b32 v17, 0, v37, s[94:95]
    v_cndmask_b32 v18, 0, v38, s[94:95]
    v_cndmask_b32 v19, 0, v39, s[94:95]
    s_mov_b32 s94, 0xf000f0
    s_mov_b32 s95, 0xf000f0
    v_cndmask_b32 v20, 0, v36, s[94:95]
    v_cndmask_b32 v21, 0, v37, s[94:95]
    v_cndmask_b32 v22, 0, v38, s[94:95]
    v_cndmask_b32 v23, 0, v39, s[94:95]
    s_mov_b32 s94, 0xf000f00
    s_mov_b32 s95, 0xf000f00
    v_cndmask_b32 v24, 0, v36, s[94:95]
    v_cndmask_b32 v25, 0, v37, s[94:95]
    v_cndmask_b32 v26, 0, v38, s[94:95]
    v_cndmask_b32 v27, 0, v39, s[94:95]
    s_mov_b32 s94, 0xf000f000
    s_mov_b32 s95, 0xf000f000
    v_cndmask_b32 v28, 0, v36, s[94:95]
    v_cndmask_b32 v29, 0, v37, s[94:95]
    v_cndmask_b32 v30, 0, v38, s[94:95]
    v_cndmask_b32 v31, 0, v39, s[94:95]
    v_mfma_f32_16x16x32_bf16 v[48:51], v[136:139], v[16:19], 0
    v_mfma_f32_16x16x32_bf16 v[48:51], v[140:143], v[20:23], v[48:51]
    v_mfma_f32_16x16x32_bf16 v[48:51], v[144:147], v[24:27], v[48:51]
    v_mfma_f32_16x16x32_bf16 v[48:51], v[148:151], v[28:31], v[48:51]
    v_mov_b32_dpp v43, v52 quad_perm:[0,0,0,0] row_mask:0xf bank_mask:0xf
    s_nop 1
    v_add_f32_dpp v43, v53, v43 quad_perm:[1,1,1,1] row_mask:0xf bank_mask:0xf
    s_nop 1
    v_add_f32_dpp v43, v54, v43 quad_perm:[2,2,2,2] row_mask:0xf bank_mask:0xf
    s_nop 1
    v_add_f32_dpp v43, v55, v43 quad_perm:[3,3,3,3] row_mask:0xf bank_mask:0xf
    v_mfma_f32_16x16x32_bf16 v[52:55], v[152:155], v[16:19], 0
    v_mfma_f32_16x16x32_bf16 v[52:55], v[156:159], v[20:23], v[52:55]
    v_mfma_f32_16x16x32_bf16 v[52:55], v[160:163], v[24:27], v[52:55]
    v_mfma_f32_16x16x32_bf16 v[52:55], v[164:167], v[28:31], v[52:55]
    v_mov_b32_dpp v44, v48 quad_perm:[0,0,0,0] row_mask:0xf bank_mask:0xf
    s_nop 1
    v_add_f32_dpp v44, v49, v44 quad_perm:[1,1,1,1] row_mask:0xf bank_mask:0xf
    s_nop 1
    v_add_f32_dpp v44, v50, v44 quad_perm:[2,2,2,2] row_mask:0xf bank_mask:0xf
    s_nop 1
    v_add_f32_dpp v44, v51, v44 quad_perm:[3,3,3,3] row_mask:0xf bank_mask:0xf
    s_waitcnt vmcnt(0)
    s_add_u32 s12, s8, 0x2018000
    buffer_load_dwordx4 v[88:91], v2, s[44:47], s12 offen offset:0 nt
    buffer_load_dwordx4 v[92:95], v2, s[44:47], s12 offen offset:1024 nt
    buffer_load_dwordx4 v[96:99], v2, s[44:47], s12 offen offset:2048 nt
    buffer_load_dwordx4 v[100:103], v2, s[44:47], s12 offen offset:3072 nt
    v_mfma_f32_16x16x32_bf16 v[48:51], v[72:75], v[16:19], 0
    v_mfma_f32_16x16x32_bf16 v[48:51], v[76:79], v[20:23], v[48:51]
    v_mfma_f32_16x16x32_bf16 v[48:51], v[80:83], v[24:27], v[48:51]
    v_mfma_f32_16x16x32_bf16 v[48:51], v[84:87], v[28:31], v[48:51]
    v_mov_b32_dpp v45, v52 quad_perm:[0,0,0,0] row_mask:0xf bank_mask:0xf
    s_nop 1
    v_add_f32_dpp v45, v53, v45 quad_perm:[1,1,1,1] row_mask:0xf bank_mask:0xf
    s_nop 1
    v_add_f32_dpp v45, v54, v45 quad_perm:[2,2,2,2] row_mask:0xf bank_mask:0xf
    s_nop 1
    v_add_f32_dpp v45, v55, v45 quad_perm:[3,3,3,3] row_mask:0xf bank_mask:0xf
    s_waitcnt vmcnt(0)
    s_add_u32 s12, s8, 0x0
    buffer_load_dwordx4 v[104:107], v3, s[48:51], s12 offen offset:0 nt
    buffer_load_dwordx4 v[108:111], v3, s[48:51], s12 offen offset:1024 nt
    buffer_load_dwordx4 v[112:115], v3, s[48:51], s12 offen offset:2048 nt
    buffer_load_dwordx4 v[116:119], v3, s[48:51], s12 offen offset:3072 nt
    v_mfma_f32_16x16x32_bf16 v[52:55], v[88:91], v[16:19], 0
    v_mfma_f32_16x16x32_bf16 v[52:55], v[92:95], v[20:23], v[52:55]
    v_mfma_f32_16x16x32_bf16 v[52:55], v[96:99], v[24:27], v[52:55]
    v_mfma_f32_16x16x32_bf16 v[52:55], v[100:103], v[28:31], v[52:55]
    v_mov_b32_dpp v46, v48 quad_perm:[0,0,0,0] row_mask:0xf bank_mask:0xf
    s_nop 1
    v_add_f32_dpp v46, v49, v46 quad_perm:[1,1,1,1] row_mask:0xf bank_mask:0xf
    s_nop 1
    v_add_f32_dpp v46, v50, v46 quad_perm:[2,2,2,2] row_mask:0xf bank_mask:0xf
    s_nop 1
    v_add_f32_dpp v46, v51, v46 quad_perm:[3,3,3,3] row_mask:0xf bank_mask:0xf
    v_mov_b32_dpp v47, v52 quad_perm:[0,0,0,0] row_mask:0xf bank_mask:0xf
    s_nop 1
    v_add_f32_dpp v47, v53, v47 quad_perm:[1,1,1,1] row_mask:0xf bank_mask:0xf
    s_nop 1
    v_add_f32_dpp v47, v54, v47 quad_perm:[2,2,2,2] row_mask:0xf bank_mask:0xf
    s_nop 1
    v_add_f32_dpp v47, v55, v47 quad_perm:[3,3,3,3] row_mask:0xf bank_mask:0xf
    v_max3_f32 v18, v40, v41, v42
    v_max_f32 v18, v18, v43
    v_max3_f32 v19, v44, v45, v46
    v_max_f32 v19, v19, v47
    v_max_f32_dpp v18, v18, v18 row_ror:4 row_mask:0xf bank_mask:0xf
    s_nop 0
    v_max_f32_dpp v19, v19, v19 row_ror:4 row_mask:0xf bank_mask:0xf
    v_max_f32_dpp v18, v18, v18 row_ror:8 row_mask:0xf bank_mask:0xf
    s_nop 0
    v_max_f32_dpp v19, v19, v19 row_ror:8 row_mask:0xf bank_mask:0xf
    v_mov_b32 v64, v18
    v_mov_b32 v65, v19
    s_nop 0
    v_permlane16_swap_b32 v18, v64
    v_permlane16_swap_b32 v19, v65
    v_max_f32 v18, v18, v64
    v_max_f32 v19, v19, v65
    v_mov_b32 v64, v18
    v_mov_b32 v65, v19
    s_nop 0
    v_permlane32_swap_b32 v18, v64
    v_permlane32_swap_b32 v19, v65
    v_max_f32 v18, v18, v64
    v_max_f32 v19, v19, v65
    v_mul_f32 v18, s91, v18
    v_mul_f32 v19, s91, v19
    v_fma_f32 v40, v40, s91, -v18
    v_fma_f32 v41, v41, s91, -v18
    v_fma_f32 v42, v42, s91, -v18
    v_fma_f32 v43, v43, s91, -v18
    v_fma_f32 v44, v44, s91, -v19
    v_fma_f32 v45, v45, s91, -v19
    v_fma_f32 v46, v46, s91, -v19
    v_fma_f32 v47, v47, s91, -v19
    v_exp_f32 v40, v40
    v_exp_f32 v41, v41
    v_exp_f32 v42, v42
    v_exp_f32 v43, v43
    v_exp_f32 v44, v44
    v_exp_f32 v45, v45
    v_exp_f32 v46, v46
    v_exp_f32 v47, v47
    v_add_f32 v16, v40, v41
    v_add_f32 v16, v16, v42
    v_add_f32 v16, v16, v43
    v_add_f32 v17, v44, v45
    v_add_f32 v17, v17, v46
    v_add_f32 v17, v17, v47
    v_cvt_pk_bf16_f32 v40, v40, v40
    v_cvt_pk_bf16_f32 v41, v41, v41
    v_cvt_pk_bf16_f32 v42, v42, v42
    v_cvt_pk_bf16_f32 v43, v43, v43
    v_cvt_pk_bf16_f32 v44, v44, v44
    v_cvt_pk_bf16_f32 v45, v45, v45
    v_cvt_pk_bf16_f32 v46, v46, v46
    v_cvt_pk_bf16_f32 v47, v47, v47
    s_waitcnt vmcnt(0)
    s_add_u32 s12, s8, 0x8000
    buffer_load_dwordx4 v[120:123], v3, s[48:51], s12 offen offset:0 nt
    buffer_load_dwordx4 v[124:127], v3, s[48:51], s12 offen offset:1024 nt
    buffer_load_dwordx4 v[128:131], v3, s[48:51], s12 offen offset:2048 nt
    buffer_load_dwordx4 v[132:135], v3, s[48:51], s12 offen offset:3072 nt
    v_add_f32_dpp v16, v16, v16 row_ror:4 row_mask:0xf bank_mask:0xf
    v_add_f32_dpp v17, v17, v17 row_ror:4 row_mask:0xf bank_mask:0xf
    s_nop 0
    v_add_f32_dpp v16, v16, v16 row_ror:8 row_mask:0xf bank_mask:0xf
    v_add_f32_dpp v17, v17, v17 row_ror:8 row_mask:0xf bank_mask:0xf
    v_mov_b32 v64, v16
    v_mov_b32 v65, v17
    s_nop 0
    v_permlane16_swap_b32 v16, v64
    v_permlane16_swap_b32 v17, v65
    v_add_f32 v16, v16, v64
    v_add_f32 v17, v17, v65
    v_mov_b32 v64, v16
    v_mov_b32 v65, v17
    s_nop 0
    v_permlane32_swap_b32 v16, v64
    v_permlane32_swap_b32 v17, v65
    v_add_f32 v16, v16, v64
    v_add_f32 v17, v17, v65
    s_lshl_b32 s9, s14, 4
    v_mov_b32 v64, s9
    ds_write_b128 v64, v[16:19] offset:0
    v_and_b32_dpp v8, v40, v4 row_newbcast:0 row_mask:0xf bank_mask:0xf
    v_and_b32_dpp v9, v40, v5 row_newbcast:0 row_mask:0xf bank_mask:0xf
    v_and_b32_dpp v10, v40, v6 row_newbcast:0 row_mask:0xf bank_mask:0xf
    v_and_b32_dpp v11, v40, v7 row_newbcast:0 row_mask:0xf bank_mask:0xf
    v_and_b32_dpp v12, v40, v4 row_newbcast:4 row_mask:0xf bank_mask:0xf
    v_and_b32_dpp v13, v40, v5 row_newbcast:4 row_mask:0xf bank_mask:0xf
    v_and_b32_dpp v14, v40, v6 row_newbcast:4 row_mask:0xf bank_mask:0xf
    v_and_b32_dpp v15, v40, v7 row_newbcast:4 row_mask:0xf bank_mask:0xf
    v_mfma_f32_16x16x32_bf16 v[56:59], v[8:11], v[104:107], 0
    v_and_b32_dpp v8, v40, v4 row_newbcast:8 row_mask:0xf bank_mask:0xf
    v_and_b32_dpp v9, v40, v5 row_newbcast:8 row_mask:0xf bank_mask:0xf
    v_and_b32_dpp v10, v40, v6 row_newbcast:8 row_mask:0xf bank_mask:0xf
    v_and_b32_dpp v11, v40, v7 row_newbcast:8 row_mask:0xf bank_mask:0xf
    v_mfma_f32_16x16x32_bf16 v[56:59], v[12:15], v[108:111], v[56:59]
    v_and_b32_dpp v12, v40, v4 row_newbcast:12 row_mask:0xf bank_mask:0xf
    v_and_b32_dpp v13, v40, v5 row_newbcast:12 row_mask:0xf bank_mask:0xf
    v_and_b32_dpp v14, v40, v6 row_newbcast:12 row_mask:0xf bank_mask:0xf
    v_and_b32_dpp v15, v40, v7 row_newbcast:12 row_mask:0xf bank_mask:0xf
    v_mfma_f32_16x16x32_bf16 v[56:59], v[8:11], v[112:115], v[56:59]
    v_and_b32_dpp v8, v41, v4 row_newbcast:0 row_mask:0xf bank_mask:0xf
    v_and_b32_dpp v9, v41, v5 row_newbcast:0 row_mask:0xf bank_mask:0xf
    v_and_b32_dpp v10, v41, v6 row_newbcast:0 row_mask:0xf bank_mask:0xf
    v_and_b32_dpp v11, v41, v7 row_newbcast:0 row_mask:0xf bank_mask:0xf
    v_mfma_f32_16x16x32_bf16 v[56:59], v[12:15], v[116:119], v[56:59]
    v_and_b32_dpp v12, v41, v4 row_newbcast:4 row_mask:0xf bank_mask:0xf
    v_and_b32_dpp v13, v41, v5 row_newbcast:4 row_mask:0xf bank_mask:0xf
    v_and_b32_dpp v14, v41, v6 row_newbcast:4 row_mask:0xf bank_mask:0xf
    v_and_b32_dpp v15, v41, v7 row_newbcast:4 row_mask:0xf bank_mask:0xf
    s_waitcnt vmcnt(0)
    s_add_u32 s12, s8, 0x10000
    buffer_load_dwordx4 v[136:139], v3, s[48:51], s12 offen offset:0 nt
    buffer_load_dwordx4 v[140:143], v3, s[48:51], s12 offen offset:1024 nt
    buffer_load_dwordx4 v[144:147], v3, s[48:51], s12 offen offset:2048 nt
    buffer_load_dwordx4 v[148:151], v3, s[48:51], s12 offen offset:3072 nt
    v_mfma_f32_16x16x32_bf16 v[56:59], v[8:11], v[120:123], v[56:59]
    v_and_b32_dpp v8, v41, v4 row_newbcast:8 row_mask:0xf bank_mask:0xf
    v_and_b32_dpp v9, v41, v5 row_newbcast:8 row_mask:0xf bank_mask:0xf
    v_and_b32_dpp v10, v41, v6 row_newbcast:8 row_mask:0xf bank_mask:0xf
    v_and_b32_dpp v11, v41, v7 row_newbcast:8 row_mask:0xf bank_mask:0xf
    v_mfma_f32_16x16x32_bf16 v[56:59], v[12:15], v[124:127], v[56:59]
    v_and_b32_dpp v12, v41, v4 row_newbcast:12 row_mask:0xf bank_mask:0xf
    v_and_b32_dpp v13, v41, v5 row_newbcast:12 row_mask:0xf bank_mask:0xf
    v_and_b32_dpp v14, v41, v6 row_newbcast:12 row_mask:0xf bank_mask:0xf
    v_and_b32_dpp v15, v41, v7 row_newbcast:12 row_mask:0xf bank_mask:0xf
    v_mfma_f32_16x16x32_bf16 v[56:59], v[8:11], v[128:131], v[56:59]
    v_and_b32_dpp v8, v42, v4 row_newbcast:0 row_mask:0xf bank_mask:0xf
    v_and_b32_dpp v9, v42, v5 row_newbcast:0 row_mask:0xf bank_mask:0xf
    v_and_b32_dpp v10, v42, v6 row_newbcast:0 row_mask:0xf bank_mask:0xf
    v_and_b32_dpp v11, v42, v7 row_newbcast:0 row_mask:0xf bank_mask:0xf
    v_mfma_f32_16x16x32_bf16 v[56:59], v[12:15], v[132:135], v[56:59]
    v_and_b32_dpp v12, v42, v4 row_newbcast:4 row_mask:0xf bank_mask:0xf
    v_and_b32_dpp v13, v42, v5 row_newbcast:4 row_mask:0xf bank_mask:0xf
    v_and_b32_dpp v14, v42, v6 row_newbcast:4 row_mask:0xf bank_mask:0xf
    v_and_b32_dpp v15, v42, v7 row_newbcast:4 row_mask:0xf bank_mask:0xf
    s_waitcnt vmcnt(0)
    s_add_u32 s12, s8, 0x18000
    buffer_load_dwordx4 v[152:155], v3, s[48:51], s12 offen offset:0 nt
    buffer_load_dwordx4 v[156:159], v3, s[48:51], s12 offen offset:1024 nt
    buffer_load_dwordx4 v[160:163], v3, s[48:51], s12 offen offset:2048 nt
    buffer_load_dwordx4 v[164:167], v3, s[48:51], s12 offen offset:3072 nt
    v_mfma_f32_16x16x32_bf16 v[56:59], v[8:11], v[136:139], v[56:59]
    v_subrev_u32 v0, 256, v0
    v_lshrrev_b32 v65, 5, v0
    v_and_b32 v66, 15, v1
    v_lshlrev_b32 v66, 5, v66
    v_and_b32 v67, 16, v1
    v_add_u32 v66, v66, v67
    v_lshl_add_u32 v28, v65, 9, v66
    s_add_u32 s88, s6, s5
    s_lshl_b32 s88, s88, 10
    s_add_u32 s88, s88, 0x1a0000
    v_mov_b32 v24, 0xfffff000
    v_mov_b32 v32, 0
    v_mov_b32 v33, 1
    v_bfe_u32 v35, v1, 3, 1
    v_lshlrev_b32 v35, 2, v35
    v_lshrrev_b32 v36, 3, v1
    v_lshlrev_b32 v36, 4, v36
    v_and_b32 v34, 7, v1
    v_lshlrev_b32 v34, 10, v34
    v_bfe_u32 v64, v1, 3, 1
    v_lshl_add_u32 v34, v64, 9, v34
    v_and_b32 v64, 48, v1
    v_add_u32 v34, v64, v34
    s_lshl_b32 s7, s6, 10
    s_lshl_b32 s9, s5, 6
    s_add_u32 s7, s7, s9
    s_add_u32 s7, s7, 0x1a0000
    v_and_b32_dpp v8, v42, v4 row_newbcast:8 row_mask:0xf bank_mask:0xf
    v_and_b32_dpp v9, v42, v5 row_newbcast:8 row_mask:0xf bank_mask:0xf
    v_and_b32_dpp v10, v42, v6 row_newbcast:8 row_mask:0xf bank_mask:0xf
    v_and_b32_dpp v11, v42, v7 row_newbcast:8 row_mask:0xf bank_mask:0xf
    v_mfma_f32_16x16x32_bf16 v[56:59], v[12:15], v[140:143], v[56:59]
    v_and_b32_dpp v12, v42, v4 row_newbcast:12 row_mask:0xf bank_mask:0xf
    v_and_b32_dpp v13, v42, v5 row_newbcast:12 row_mask:0xf bank_mask:0xf
    v_and_b32_dpp v14, v42, v6 row_newbcast:12 row_mask:0xf bank_mask:0xf
    v_and_b32_dpp v15, v42, v7 row_newbcast:12 row_mask:0xf bank_mask:0xf
    v_mfma_f32_16x16x32_bf16 v[56:59], v[8:11], v[144:147], v[56:59]
    v_and_b32_dpp v8, v43, v4 row_newbcast:0 row_mask:0xf bank_mask:0xf
    v_and_b32_dpp v9, v43, v5 row_newbcast:0 row_mask:0xf bank_mask:0xf
    v_and_b32_dpp v10, v43, v6 row_newbcast:0 row_mask:0xf bank_mask:0xf
    v_and_b32_dpp v11, v43, v7 row_newbcast:0 row_mask:0xf bank_mask:0xf
    v_mfma_f32_16x16x32_bf16 v[56:59], v[12:15], v[148:151], v[56:59]
    v_and_b32_dpp v12, v43, v4 row_newbcast:4 row_mask:0xf bank_mask:0xf
    v_and_b32_dpp v13, v43, v5 row_newbcast:4 row_mask:0xf bank_mask:0xf
    v_and_b32_dpp v14, v43, v6 row_newbcast:4 row_mask:0xf bank_mask:0xf
    v_and_b32_dpp v15, v43, v7 row_newbcast:4 row_mask:0xf bank_mask:0xf
    s_waitcnt vmcnt(0)
    s_add_u32 s12, s8, 0x2000000
    buffer_load_dwordx4 v[72:75], v3, s[48:51], s12 offen offset:0 nt
    buffer_load_dwordx4 v[76:79], v3, s[48:51], s12 offen offset:1024 nt
    buffer_load_dwordx4 v[80:83], v3, s[48:51], s12 offen offset:2048 nt
    buffer_load_dwordx4 v[84:87], v3, s[48:51], s12 offen offset:3072 nt
    v_mfma_f32_16x16x32_bf16 v[56:59], v[8:11], v[152:155], v[56:59]
    v_lshrrev_b32 v31, 3, v1
    v_lshl_add_u32 v31, v31, 3, s14
    v_mul_u32_u24 v31, 0x1200, v31
    v_and_b32 v64, 7, v0
    v_lshl_add_u32 v31, v64, 4, v31
    v_lshlrev_b32 v25, 4, v64
    s_lshl_b32 s9, s14, 7
    v_add_u32 v25, s9, v25
    v_and_b32 v26, 31, v1
    v_lshlrev_b32 v27, 1, v26
    v_lshlrev_b32 v26, 2, v26
    v_lshrrev_b32 v64, 5, v1
    v_lshl_add_u32 v26, v64, 9, v26
    v_add_u32 v26, 13888, v26
    v_and_b32_dpp v8, v43, v4 row_newbcast:8 row_mask:0xf bank_mask:0xf
    v_and_b32_dpp v9, v43, v5 row_newbcast:8 row_mask:0xf bank_mask:0xf
    v_and_b32_dpp v10, v43, v6 row_newbcast:8 row_mask:0xf bank_mask:0xf
    v_and_b32_dpp v11, v43, v7 row_newbcast:8 row_mask:0xf bank_mask:0xf
    v_mfma_f32_16x16x32_bf16 v[56:59], v[12:15], v[156:159], v[56:59]
    v_and_b32_dpp v12, v43, v4 row_newbcast:12 row_mask:0xf bank_mask:0xf
    v_and_b32_dpp v13, v43, v5 row_newbcast:12 row_mask:0xf bank_mask:0xf
    v_and_b32_dpp v14, v43, v6 row_newbcast:12 row_mask:0xf bank_mask:0xf
    v_and_b32_dpp v15, v43, v7 row_newbcast:12 row_mask:0xf bank_mask:0xf
    v_mfma_f32_16x16x32_bf16 v[56:59], v[8:11], v[160:163], v[56:59]
    v_and_b32_dpp v8, v44, v4 row_newbcast:0 row_mask:0xf bank_mask:0xf
    v_and_b32_dpp v9, v44, v5 row_newbcast:0 row_mask:0xf bank_mask:0xf
    v_and_b32_dpp v10, v44, v6 row_newbcast:0 row_mask:0xf bank_mask:0xf
    v_and_b32_dpp v11, v44, v7 row_newbcast:0 row_mask:0xf bank_mask:0xf
    v_mfma_f32_16x16x32_bf16 v[56:59], v[12:15], v[164:167], v[56:59]
    v_and_b32_dpp v12, v44, v4 row_newbcast:4 row_mask:0xf bank_mask:0xf
    v_and_b32_dpp v13, v44, v5 row_newbcast:4 row_mask:0xf bank_mask:0xf
    v_and_b32_dpp v14, v44, v6 row_newbcast:4 row_mask:0xf bank_mask:0xf
    v_and_b32_dpp v15, v44, v7 row_newbcast:4 row_mask:0xf bank_mask:0xf
    s_waitcnt vmcnt(0)
    s_add_u32 s12, s8, 0x2008000
    buffer_load_dwordx4 v[88:91], v3, s[48:51], s12 offen offset:0 nt
    buffer_load_dwordx4 v[92:95], v3, s[48:51], s12 offen offset:1024 nt
    buffer_load_dwordx4 v[96:99], v3, s[48:51], s12 offen offset:2048 nt
    buffer_load_dwordx4 v[100:103], v3, s[48:51], s12 offen offset:3072 nt
    v_mfma_f32_16x16x32_bf16 v[60:63], v[8:11], v[72:75], 0
    v_and_b32_dpp v8, v44, v4 row_newbcast:8 row_mask:0xf bank_mask:0xf
    v_and_b32_dpp v9, v44, v5 row_newbcast:8 row_mask:0xf bank_mask:0xf
    v_and_b32_dpp v10, v44, v6 row_newbcast:8 row_mask:0xf bank_mask:0xf
    v_and_b32_dpp v11, v44, v7 row_newbcast:8 row_mask:0xf bank_mask:0xf
    v_mfma_f32_16x16x32_bf16 v[60:63], v[12:15], v[76:79], v[60:63]
    v_and_b32_dpp v12, v44, v4 row_newbcast:12 row_mask:0xf bank_mask:0xf
    v_and_b32_dpp v13, v44, v5 row_newbcast:12 row_mask:0xf bank_mask:0xf
    v_and_b32_dpp v14, v44, v6 row_newbcast:12 row_mask:0xf bank_mask:0xf
    v_and_b32_dpp v15, v44, v7 row_newbcast:12 row_mask:0xf bank_mask:0xf
    v_mfma_f32_16x16x32_bf16 v[60:63], v[8:11], v[80:83], v[60:63]
    v_and_b32_dpp v8, v45, v4 row_newbcast:0 row_mask:0xf bank_mask:0xf
    v_and_b32_dpp v9, v45, v5 row_newbcast:0 row_mask:0xf bank_mask:0xf
    v_and_b32_dpp v10, v45, v6 row_newbcast:0 row_mask:0xf bank_mask:0xf
    v_and_b32_dpp v11, v45, v7 row_newbcast:0 row_mask:0xf bank_mask:0xf
    v_mfma_f32_16x16x32_bf16 v[60:63], v[12:15], v[84:87], v[60:63]
    v_and_b32_dpp v12, v45, v4 row_newbcast:4 row_mask:0xf bank_mask:0xf
    v_and_b32_dpp v13, v45, v5 row_newbcast:4 row_mask:0xf bank_mask:0xf
    v_and_b32_dpp v14, v45, v6 row_newbcast:4 row_mask:0xf bank_mask:0xf
    v_and_b32_dpp v15, v45, v7 row_newbcast:4 row_mask:0xf bank_mask:0xf
    s_waitcnt vmcnt(0)
    s_add_u32 s12, s8, 0x2010000
    buffer_load_dwordx4 v[104:107], v3, s[48:51], s12 offen offset:0 nt
    buffer_load_dwordx4 v[108:111], v3, s[48:51], s12 offen offset:1024 nt
    buffer_load_dwordx4 v[112:115], v3, s[48:51], s12 offen offset:2048 nt
    buffer_load_dwordx4 v[116:119], v3, s[48:51], s12 offen offset:3072 nt
    v_mfma_f32_16x16x32_bf16 v[60:63], v[8:11], v[88:91], v[60:63]
    v_and_b32 v65, 7, v1
    v_lshlrev_b32 v65, 4, v65
    s_mov_b32 s13, 0x40000
    s_branch L_ls_go
L_ls_spin:
    s_sleep 1
L_ls_go:
    ds_read_b128 v[20:23], v65 offset:0
    s_waitcnt lgkmcnt(0)
L_ls_chk:
    v_min_u32 v64, v20, v21
    v_cmp_eq_u32 vcc, 0, v64
    s_sub_u32 s13, s13, 1
    s_cbranch_scc1 L_ls_ok
    s_cbranch_vccnz L_ls_spin
L_ls_ok:
    ds_read_b32 v37, v35 offset:768
    v_mov_b32 v48, v22
    v_mov_b32 v49, v23
    s_nop 0
    v_max_f32_dpp v48, v48, v48 quad_perm:[1,0,3,2] row_mask:0xf bank_mask:0xf
    v_max_f32_dpp v49, v49, v49 quad_perm:[1,0,3,2] row_mask:0xf bank_mask:0xf
    s_nop 0
    v_max_f32_dpp v48, v48, v48 quad_perm:[2,3,0,1] row_mask:0xf bank_mask:0xf
    v_max_f32_dpp v49, v49, v49 quad_perm:[2,3,0,1] row_mask:0xf bank_mask:0xf
    s_nop 0
    v_max_f32_dpp v48, v48, v48 row_half_mirror row_mask:0xf bank_mask:0xf
    v_max_f32_dpp v49, v49, v49 row_half_mirror row_mask:0xf bank_mask:0xf
    v_sub_f32 v22, v22, v48
    v_sub_f32 v18, v18, v48
    v_sub_f32 v23, v23, v49
    v_sub_f32 v19, v19, v49
    v_exp_f32 v22, v22
    v_exp_f32 v23, v23
    v_exp_f32 v18, v18
    v_exp_f32 v29, v19
    v_mul_f32 v20, v20, v22
    v_mul_f32 v21, v21, v23
    v_mul_f32 v56, v56, v18
    v_mul_f32 v57, v57, v18
    v_mul_f32 v58, v58, v18
    v_mul_f32 v59, v59, v18
    v_and_b32_dpp v8, v45, v4 row_newbcast:8 row_mask:0xf bank_mask:0xf
    v_and_b32_dpp v9, v45, v5 row_newbcast:8 row_mask:0xf bank_mask:0xf
    v_and_b32_dpp v10, v45, v6 row_newbcast:8 row_mask:0xf bank_mask:0xf
    v_and_b32_dpp v11, v45, v7 row_newbcast:8 row_mask:0xf bank_mask:0xf
    v_mfma_f32_16x16x32_bf16 v[60:63], v[12:15], v[92:95], v[60:63]
    v_and_b32_dpp v12, v45, v4 row_newbcast:12 row_mask:0xf bank_mask:0xf
    v_and_b32_dpp v13, v45, v5 row_newbcast:12 row_mask:0xf bank_mask:0xf
    v_and_b32_dpp v14, v45, v6 row_newbcast:12 row_mask:0xf bank_mask:0xf
    v_and_b32_dpp v15, v45, v7 row_newbcast:12 row_mask:0xf bank_mask:0xf
    v_mfma_f32_16x16x32_bf16 v[60:63], v[8:11], v[96:99], v[60:63]
    v_add_f32_dpp v20, v20, v20 quad_perm:[1,0,3,2] row_mask:0xf bank_mask:0xf
    v_add_f32_dpp v21, v21, v21 quad_perm:[1,0,3,2] row_mask:0xf bank_mask:0xf
    s_nop 0
    v_add_f32_dpp v20, v20, v20 quad_perm:[2,3,0,1] row_mask:0xf bank_mask:0xf
    v_add_f32_dpp v21, v21, v21 quad_perm:[2,3,0,1] row_mask:0xf bank_mask:0xf
    s_nop 0
    v_add_f32_dpp v20, v20, v20 row_half_mirror row_mask:0xf bank_mask:0xf
    v_add_f32_dpp v21, v21, v21 row_half_mirror row_mask:0xf bank_mask:0xf
    v_cmp_eq_u32 vcc, 1, v1
    s_nop 1
    v_cndmask_b32 v48, v48, v49, vcc
    v_cndmask_b32 v50, v20, v21, vcc
    v_mov_b32 v49, s86
    v_mov_b32 v51, s87
    s_add_u32 s80, s6, s5
    s_lshl_b32 s80, s80, 7
    s_add_u32 s80, s80, 0x1e0000
    s_lshl_b32 s81, s6, 7
    s_add_u32 s81, s81, 0x1e0000
    v_and_b32 v38, 7, v1
    v_lshlrev_b32 v38, 7, v38
    v_lshl_add_u32 v38, v35, 2, v38
    s_waitcnt vmcnt(0)
    s_add_u32 s12, s8, 0x2018000
    buffer_load_dwordx4 v[120:123], v3, s[48:51], s12 offen offset:0 nt
    buffer_load_dwordx4 v[124:127], v3, s[48:51], s12 offen offset:1024 nt
    buffer_load_dwordx4 v[128:131], v3, s[48:51], s12 offen offset:2048 nt
    buffer_load_dwordx4 v[132:135], v3, s[48:51], s12 offen offset:3072 nt
    v_and_b32_dpp v8, v46, v4 row_newbcast:0 row_mask:0xf bank_mask:0xf
    v_and_b32_dpp v9, v46, v5 row_newbcast:0 row_mask:0xf bank_mask:0xf
    v_and_b32_dpp v10, v46, v6 row_newbcast:0 row_mask:0xf bank_mask:0xf
    v_and_b32_dpp v11, v46, v7 row_newbcast:0 row_mask:0xf bank_mask:0xf
    v_mfma_f32_16x16x32_bf16 v[60:63], v[12:15], v[100:103], v[60:63]
    v_and_b32_dpp v12, v46, v4 row_newbcast:4 row_mask:0xf bank_mask:0xf
    v_and_b32_dpp v13, v46, v5 row_newbcast:4 row_mask:0xf bank_mask:0xf
    v_and_b32_dpp v14, v46, v6 row_newbcast:4 row_mask:0xf bank_mask:0xf
    v_and_b32_dpp v15, v46, v7 row_newbcast:4 row_mask:0xf bank_mask:0xf
    v_mfma_f32_16x16x32_bf16 v[60:63], v[8:11], v[104:107], v[60:63]
    v_and_b32_dpp v8, v46, v4 row_newbcast:8 row_mask:0xf bank_mask:0xf
    v_and_b32_dpp v9, v46, v5 row_newbcast:8 row_mask:0xf bank_mask:0xf
    v_and_b32_dpp v10, v46, v6 row_newbcast:8 row_mask:0xf bank_mask:0xf
    v_and_b32_dpp v11, v46, v7 row_newbcast:8 row_mask:0xf bank_mask:0xf
    v_mfma_f32_16x16x32_bf16 v[60:63], v[12:15], v[108:111], v[60:63]
    v_and_b32_dpp v12, v46, v4 row_newbcast:12 row_mask:0xf bank_mask:0xf
    v_and_b32_dpp v13, v46, v5 row_newbcast:12 row_mask:0xf bank_mask:0xf
    v_and_b32_dpp v14, v46, v6 row_newbcast:12 row_mask:0xf bank_mask:0xf
    v_and_b32_dpp v15, v46, v7 row_newbcast:12 row_mask:0xf bank_mask:0xf
    v_mfma_f32_16x16x32_bf16 v[60:63], v[8:11], v[112:115], v[60:63]
    v_mov_b32 v64, 0
    v_mov_b32 v65, 1
    s_mov_b64 exec, 1
    ds_add_u32 v64, v65 offset:132
    s_mov_b64 exec, -1
    s_setprio 2
    v_and_b32_dpp v8, v47, v4 row_newbcast:0 row_mask:0xf bank_mask:0xf
    v_and_b32_dpp v9, v47, v5 row_newbcast:0 row_mask:0xf bank_mask:0xf
    v_and_b32_dpp v10, v47, v6 row_newbcast:0 row_mask:0xf bank_mask:0xf
    v_and_b32_dpp v11, v47, v7 row_newbcast:0 row_mask:0xf bank_mask:0xf
    v_mfma_f32_16x16x32_bf16 v[60:63], v[12:15], v[116:119], v[60:63]
    v_and_b32_dpp v12, v47, v4 row_newbcast:4 row_mask:0xf bank_mask:0xf
    v_and_b32_dpp v13, v47, v5 row_newbcast:4 row_mask:0xf bank_mask:0xf
    v_and_b32_dpp v14, v47, v6 row_newbcast:4 row_mask:0xf bank_mask:0xf
    v_and_b32_dpp v15, v47, v7 row_newbcast:4 row_mask:0xf bank_mask:0xf
    s_waitcnt vmcnt(3)
    v_mfma_f32_16x16x32_bf16 v[60:63], v[8:11], v[120:123], v[60:63]
    v_and_b32_dpp v8, v47, v4 row_newbcast:8 row_mask:0xf bank_mask:0xf
    v_and_b32_dpp v9, v47, v5 row_newbcast:8 row_mask:0xf bank_mask:0xf
    v_and_b32_dpp v10, v47, v6 row_newbcast:8 row_mask:0xf bank_mask:0xf
    v_and_b32_dpp v11, v47, v7 row_newbcast:8 row_mask:0xf bank_mask:0xf
    s_waitcnt vmcnt(2)
    v_mfma_f32_16x16x32_bf16 v[60:63], v[12:15], v[124:127], v[60:63]
    v_and_b32_dpp v12, v47, v4 row_newbcast:12 row_mask:0xf bank_mask:0xf
    v_and_b32_dpp v13, v47, v5 row_newbcast:12 row_mask:0xf bank_mask:0xf
    v_and_b32_dpp v14, v47, v6 row_newbcast:12 row_mask:0xf bank_mask:0xf
    v_and_b32_dpp v15, v47, v7 row_newbcast:12 row_mask:0xf bank_mask:0xf
    s_waitcnt vmcnt(1)
    v_mfma_f32_16x16x32_bf16 v[60:63], v[8:11], v[128:131], v[60:63]
    s_waitcnt vmcnt(0)
    v_mfma_f32_16x16x32_bf16 v[60:63], v[12:15], v[132:135], v[60:63]
    s_mov_b32 exec_lo, 0
    s_nop 6
    v_mul_f32 v56, v60, v29
    v_mul_f32 v57, v61, v29
    v_mul_f32 v58, v62, v29
    v_mul_f32 v59, v63, v29
    s_mov_b32 exec_lo, -1
    ds_write_b128 v28, v[56:59] offset:5696
    s_mov_b64 exec, 1
    ds_add_rtn_u32 v64, v32, v33 offset:140
    s_mov_b64 exec, -1
    s_waitcnt lgkmcnt(0)
    v_readfirstlane_b32 s9, v64
    s_nop 1
    s_cmp_lg_u32 s9, 7
    s_cbranch_scc1 L_pubbed
    ds_read_b128 v[72:75], v3 offset:5696
    ds_read_b128 v[76:79], v3 offset:6720
    ds_read_b128 v[80:83], v3 offset:7744
    ds_read_b128 v[84:87], v3 offset:8768
    ds_read_b128 v[88:91], v3 offset:9792
    ds_read_b128 v[92:95], v3 offset:10816
    ds_read_b128 v[96:99], v3 offset:11840
    ds_read_b128 v[100:103], v3 offset:12864
    s_waitcnt lgkmcnt(6)
    v_pk_add_f32 v[72:73], v[72:73], v[76:77]
    v_pk_add_f32 v[74:75], v[74:75], v[78:79]
    s_waitcnt lgkmcnt(4)
    v_pk_add_f32 v[80:81], v[80:81], v[84:85]
    v_pk_add_f32 v[82:83], v[82:83], v[86:87]
    s_waitcnt lgkmcnt(2)
    v_pk_add_f32 v[88:89], v[88:89], v[92:93]
    v_pk_add_f32 v[90:91], v[90:91], v[94:95]
    s_waitcnt lgkmcnt(0)
    v_pk_add_f32 v[96:97], v[96:97], v[100:101]
    v_pk_add_f32 v[98:99], v[98:99], v[102:103]
    v_pk_add_f32 v[72:73], v[72:73], v[80:81]
    v_pk_add_f32 v[74:75], v[74:75], v[82:83]
    v_pk_add_f32 v[88:89], v[88:89], v[96:97]
    v_pk_add_f32 v[90:91], v[90:91], v[98:99]
    v_pk_add_f32 v[72:73], v[72:73], v[88:89]
    v_pk_add_f32 v[74:75], v[74:75], v[90:91]
    v_add_u32 v72, 0x800, v72
    v_add_u32 v73, 0x800, v73
    v_add_u32 v74, 0x800, v74
    v_add_u32 v75, 0x800, v75
    v_and_or_b32 v72, v72, v24, s72
    v_and_or_b32 v73, v73, v24, s73
    v_and_or_b32 v74, v74, v24, s74
    v_and_or_b32 v75, v75, v24, s75
    s_cmp_lg_u32 s82, 0
    s_cbranch_scc1 L_far
    buffer_store_dwordx4 v[72:75], v3, s[68:71], s88 offen
    s_mov_b64 exec, 255
    buffer_store_dwordx4 v[48:51], v3, s[68:71], s80 offen
    s_mov_b64 exec, -1
    s_branch L_near
L_far:
    buffer_store_dwordx4 v[72:75], v3, s[68:71], s88 offen sc1
    s_mov_b64 exec, 255
    buffer_store_dwordx4 v[48:51], v3, s[68:71], s80 offen sc1
    s_mov_b64 exec, -1
L_near:
    ds_write_b32 v32, v33 offset:144
    s_mov_b32 s13, 0x40000
    s_branch L_o_go
L_o_spin:
    s_mov_b64 exec, vcc
L_o_go:
    buffer_load_dwordx4 v[112:115], v38, s[68:71], s81 offen sc1
    buffer_load_dwordx4 v[108:111], v34, s[68:71], s7 offen sc1
    s_waitcnt vmcnt(0)
L_o_chk:
    v_xor_b32 v108, s72, v108
    v_xor_b32 v109, s73, v109
    v_xor_b32 v110, s74, v110
    v_xor_b32 v111, s75, v111
    v_xor_b32 v113, s86, v113
    v_xor_b32 v115, s87, v115
    v_or3_b32 v64, v108, v109, v110
    v_or_b32 v64, v64, v111
    v_and_b32 v64, 0xfff, v64
    v_or3_b32 v64, v64, v113, v115
    v_cmp_ne_u32 vcc, 0, v64
    s_sub_u32 s13, s13, 1
    s_cbranch_scc1 L_o_ok
    s_cbranch_vccnz L_o_spin
L_o_ok:
    s_mov_b64 exec, -1
    v_max_f32_dpp v65, v112, v112 quad_perm:[1,0,3,2] row_mask:0xf bank_mask:0xf
    s_nop 1
    v_max_f32_dpp v65, v65, v65 quad_perm:[2,3,0,1] row_mask:0xf bank_mask:0xf
    s_nop 1
    v_max_f32_dpp v65, v65, v65 row_half_mirror row_mask:0xf bank_mask:0xf
    v_sub_f32 v65, v112, v65
    v_exp_f32 v65, v65
    s_nop 0
    v_mul_f32 v114, v114, v65
    v_mul_f32 v108, v108, v65
    v_mul_f32 v109, v109, v65
    v_mul_f32 v110, v110, v65
    v_mul_f32 v111, v111, v65
    v_add_f32_dpp v114, v114, v114 quad_perm:[1,0,3,2] row_mask:0xf bank_mask:0xf
    v_add_f32_dpp v108, v108, v108 quad_perm:[1,0,3,2] row_mask:0xf bank_mask:0xf
    v_add_f32_dpp v109, v109, v109 quad_perm:[1,0,3,2] row_mask:0xf bank_mask:0xf
    v_add_f32_dpp v110, v110, v110 quad_perm:[1,0,3,2] row_mask:0xf bank_mask:0xf
    v_add_f32_dpp v111, v111, v111 quad_perm:[1,0,3,2] row_mask:0xf bank_mask:0xf
    v_add_f32_dpp v114, v114, v114 quad_perm:[2,3,0,1] row_mask:0xf bank_mask:0xf
    v_add_f32_dpp v108, v108, v108 quad_perm:[2,3,0,1] row_mask:0xf bank_mask:0xf
    v_add_f32_dpp v109, v109, v109 quad_perm:[2,3,0,1] row_mask:0xf bank_mask:0xf
    v_add_f32_dpp v110, v110, v110 quad_perm:[2,3,0,1] row_mask:0xf bank_mask:0xf
    v_add_f32_dpp v111, v111, v111 quad_perm:[2,3,0,1] row_mask:0xf bank_mask:0xf
    v_add_f32_dpp v114, v114, v114 row_half_mirror row_mask:0xf bank_mask:0xf
    v_add_f32_dpp v108, v108, v108 row_half_mirror row_mask:0xf bank_mask:0xf
    v_add_f32_dpp v109, v109, v109 row_half_mirror row_mask:0xf bank_mask:0xf
    v_add_f32_dpp v110, v110, v110 row_half_mirror row_mask:0xf bank_mask:0xf
    v_add_f32_dpp v111, v111, v111 row_half_mirror row_mask:0xf bank_mask:0xf
    v_rcp_f32 v65, v114
    s_nop 0
    v_mul_f32 v65, v65, v37
    v_mul_f32 v108, v108, v65
    v_mul_f32 v109, v109, v65
    v_mul_f32 v110, v110, v65
    v_mul_f32 v111, v111, v65
    v_cvt_pk_bf16_f32 v108, v108, v108
    v_cvt_pk_bf16_f32 v109, v109, v109
    v_cvt_pk_bf16_f32 v110, v110, v110
    v_cvt_pk_bf16_f32 v111, v111, v111
    ds_write_b128 v36, v[108:111] offset:832
    ds_write_b32 v32, v33 offset:148
    v_mov_b32 v65, 0
    s_mov_b32 s13, 0x40000
    s_branch L_fy_go
L_fy_spin:
    s_sleep 2
L_fy_go:
    ds_read_b32 v64, v65 offset:148
    s_waitcnt lgkmcnt(0)
L_fy_chk:
    v_cmp_gt_u32 vcc, 5, v64
    s_sub_u32 s13, s13, 1
    s_cbranch_scc1 L_fy_ok
    s_cbranch_vccnz L_fy_spin
L_fy_ok:
    s_cmp_ge_u32 s2, 96
    s_cbranch_scc1 L_notick
    s_mov_b64 exec, 1
    global_atomic_add v66, v32, v33, s[40:41] sc0 sc1
    s_mov_b64 exec, -1
L_notick:
    buffer_store_dwordx4 v[72:75], v3, s[68:71], s88 offen sc1
    s_mov_b64 exec, 255
    buffer_store_dwordx4 v[48:51], v3, s[68:71], s80 offen sc1
    s_mov_b64 exec, -1
    s_waitcnt vmcnt(2)
    v_add_u32 v66, 1, v66
    s_mov_b64 exec, 1
    ds_write_b32 v32, v66 offset:168
    s_mov_b64 exec, -1
L_pubbed:
    s_cmp_ge_u32 s2, 96
    s_cbranch_scc1 L_fin
    v_mov_b32 v65, 0
    s_mov_b32 s13, 0x40000
    s_branch L_ft_go
L_ft_spin:
    s_sleep 2
L_ft_go:
    ds_read_b32 v64, v65 offset:168
    s_waitcnt lgkmcnt(0)
L_ft_chk:
    v_cmp_gt_u32 vcc, 1, v64
    s_sub_u32 s13, s13, 1
    s_cbranch_scc1 L_ft_ok
    s_cbranch_vccnz L_ft_spin
L_ft_ok:
    v_readfirstlane_b32 s83, v64
    s_nop 1
    s_sub_u32 s83, s83, 1
    s_mul_hi_u32 s9, s83, 0xaaaaaaab
    s_lshr_b32 s9, s9, 6
    s_mul_i32 s9, s9, 96
    s_sub_u32 s83, s83, s9
    s_cmp_ge_u32 s83, 36
    s_cbranch_scc1 L_fin
    s_lshl_b32 s96, s83, 7
    s_add_u32 s97, s96, 294912
    s_add_u32 s98, s96, 589824
    s_add_u32 s99, s96, 884736
    s_lshl_b32 s9, s83, 6
    v_add_u32 v27, s9, v27
    s_mov_b32 exec_lo, 0x1010101
    s_mov_b32 exec_hi, 0x1010101
    s_mov_b32 s13, 0x40000
    s_branch L_w_go
L_w_spin:
    s_sleep 1
L_w_go:
    buffer_load_dwordx4 v[104:107], v31, s[68:71], s96 offen sc1
    s_waitcnt vmcnt(0)
L_w_chk:
    v_xor_b32 v104, s72, v104
    v_xor_b32 v105, s73, v105
    v_xor_b32 v106, s74, v106
    v_xor_b32 v107, s75, v107
    v_or3_b32 v13, v104, v105, v106
    v_or_b32 v13, v13, v107
    v_and_b32 v13, 0xfff, v13
    v_cmp_ne_u32 vcc, 0, v13
    s_nop 1
    s_cmp_eq_u64 vcc, exec
    s_cselect_b64 vcc, -1, 0
    s_sub_u32 s13, s13, 1
    s_cbranch_scc1 L_w_ok
    s_cbranch_vccnz L_w_spin
L_w_ok:
    s_mov_b64 exec, -1
    s_mov_b32 s13, 0x40000
    buffer_load_dwordx4 v[116:119], v31, s[68:71], s96 offen sc1
    buffer_load_dwordx4 v[120:123], v31, s[68:71], s97 offen sc1
    buffer_load_dwordx4 v[124:127], v31, s[68:71], s98 offen sc1
    buffer_load_dwordx4 v[128:131], v31, s[68:71], s99 offen sc1
    s_sleep 8
    buffer_load_dwordx4 v[132:135], v31, s[68:71], s96 offen sc1
    buffer_load_dwordx4 v[136:139], v31, s[68:71], s97 offen sc1
    buffer_load_dwordx4 v[140:143], v31, s[68:71], s98 offen sc1
    buffer_load_dwordx4 v[144:147], v31, s[68:71], s99 offen sc1
L_y_spin:
    s_waitcnt vmcnt(4)
    v_xor_b32 v116, s72, v116
    v_xor_b32 v117, s73, v117
    v_xor_b32 v118, s74, v118
    v_xor_b32 v119, s75, v119
    v_xor_b32 v120, s72, v120
    v_xor_b32 v121, s73, v121
    v_xor_b32 v122, s74, v122
    v_xor_b32 v123, s75, v123
    v_xor_b32 v124, s72, v124
    v_xor_b32 v125, s73, v125
    v_xor_b32 v126, s74, v126
    v_xor_b32 v127, s75, v127
    v_xor_b32 v128, s72, v128
    v_xor_b32 v129, s73, v129
    v_xor_b32 v130, s74, v130
    v_xor_b32 v131, s75, v131
    v_or3_b32 v13, v116, v117, v118
    v_or3_b32 v13, v13, v119, v120
    v_or3_b32 v13, v13, v121, v122
    v_or3_b32 v13, v13, v123, v124
    v_or3_b32 v13, v13, v125, v126
    v_or3_b32 v13, v13, v127, v128
    v_or3_b32 v13, v13, v129, v130
    v_or_b32 v13, v13, v131
    v_and_b32 v13, 0xfff, v13
    v_cmp_ne_u32 vcc, 0, v13
    s_nop 1
    s_andn2_b64 exec, exec, vcc
    v_pk_add_f32 v[116:117], v[116:117], v[120:121]
    v_pk_add_f32 v[124:125], v[124:125], v[128:129]
    v_pk_add_f32 v[118:119], v[118:119], v[122:123]
    v_pk_add_f32 v[126:127], v[126:127], v[130:131]
    v_pk_add_f32 v[104:105], v[116:117], v[124:125]
    v_pk_add_f32 v[106:107], v[118:119], v[126:127]
    s_cbranch_vccz L_y_ok
    s_mov_b64 exec, vcc
    buffer_load_dwordx4 v[116:119], v31, s[68:71], s96 offen sc1
    buffer_load_dwordx4 v[120:123], v31, s[68:71], s97 offen sc1
    buffer_load_dwordx4 v[124:127], v31, s[68:71], s98 offen sc1
    buffer_load_dwordx4 v[128:131], v31, s[68:71], s99 offen sc1
    s_waitcnt vmcnt(4)
    v_xor_b32 v132, s72, v132
    v_xor_b32 v133, s73, v133
    v_xor_b32 v134, s74, v134
    v_xor_b32 v135, s75, v135
    v_xor_b32 v136, s72, v136
    v_xor_b32 v137, s73, v137
    v_xor_b32 v138, s74, v138
    v_xor_b32 v139, s75, v139
    v_xor_b32 v140, s72, v140
    v_xor_b32 v141, s73, v141
    v_xor_b32 v142, s74, v142
    v_xor_b32 v143, s75, v143
    v_xor_b32 v144, s72, v144
    v_xor_b32 v145, s73, v145
    v_xor_b32 v146, s74, v146
    v_xor_b32 v147, s75, v147
    v_or3_b32 v13, v132, v133, v134
    v_or3_b32 v13, v13, v135, v136
    v_or3_b32 v13, v13, v137, v138
    v_or3_b32 v13, v13, v139, v140
    v_or3_b32 v13, v13, v141, v142
    v_or3_b32 v13, v13, v143, v144
    v_or3_b32 v13, v13, v145, v146
    v_or_b32 v13, v13, v147
    v_and_b32 v13, 0xfff, v13
    v_cmp_ne_u32 vcc, 0, v13
    s_nop 1
    s_andn2_b64 exec, exec, vcc
    v_pk_add_f32 v[132:133], v[132:133], v[136:137]
    v_pk_add_f32 v[140:141], v[140:141], v[144:145]
    v_pk_add_f32 v[134:135], v[134:135], v[138:139]
    v_pk_add_f32 v[142:143], v[142:143], v[146:147]
    v_pk_add_f32 v[104:105], v[132:133], v[140:141]
    v_pk_add_f32 v[106:107], v[134:135], v[142:143]
    s_cbranch_vccz L_y_ok
    s_mov_b64 exec, vcc
    buffer_load_dwordx4 v[132:135], v31, s[68:71], s96 offen sc1
    buffer_load_dwordx4 v[136:139], v31, s[68:71], s97 offen sc1
    buffer_load_dwordx4 v[140:143], v31, s[68:71], s98 offen sc1
    buffer_load_dwordx4 v[144:147], v31, s[68:71], s99 offen sc1
    s_sub_u32 s13, s13, 1
    s_cbranch_scc0 L_y_spin
L_y_ok:
    s_mov_b64 exec, -1
    s_nop 1
    v_add_f32_dpp v104, v104, v104 row_ror:8 row_mask:0xf bank_mask:0xf
    v_add_f32_dpp v105, v105, v105 row_ror:8 row_mask:0xf bank_mask:0xf
    v_add_f32_dpp v106, v106, v106 row_ror:8 row_mask:0xf bank_mask:0xf
    v_add_f32_dpp v107, v107, v107 row_ror:8 row_mask:0xf bank_mask:0xf
    v_permlane16_swap_b32 v104, v105
    s_nop 0
    v_permlane16_swap_b32 v106, v107
    v_add_f32 v104, v104, v105
    v_add_f32 v106, v106, v107
    s_nop 1
    v_permlane32_swap_b32 v104, v106
    v_add_f32 v104, v104, v106
    v_lshrrev_b32 v13, 4, v1
    v_lshl_add_u32 v13, v13, 2, v25
    ds_write_b32 v13, v104 offset:13888
    s_waitcnt lgkmcnt(0)
    s_barrier
    s_cmp_lg_u32 s14, 0
    s_cbranch_scc1 L_fin
    ds_read2_b32 v[104:105], v26 offset0:0 offset1:32
    ds_read2_b32 v[106:107], v26 offset0:64 offset1:96
    s_waitcnt lgkmcnt(0)
    v_add_f32 v104, v104, v105
    v_add_f32 v106, v106, v107
    v_add_f32 v104, v104, v106
    v_mov_b32 v105, v104
    s_nop 1
    v_permlane32_swap_b32 v104, v105
    v_add_f32 v104, v104, v105
    v_cvt_pk_bf16_f32 v104, v104, v104
    s_mov_b32 exec_hi, 0
    global_store_short v27, v104, s[38:39] sc1
    s_cmp_lg_u32 s83, 0
    s_cbranch_scc1 L_fin
    s_mov_b64 exec, 1
    v_mov_b32 v14, s86
    v_mov_b32 v15, s87
    v_mov_b32 v12, 0x1e8000
    global_store_dwordx2 v12, v[14:15], s[42:43] sc1
L_fin:
    s_endpgm
L_helper:
    s_add_u32 s72, s42, 0x1e8000
    s_addc_u32 s73, s43, 0
    s_load_dwordx2 s[86:87], s[72:73], 0
    s_add_u32 s62, s6, s5
    s_mul_i32 s60, s2, 9363
    s_lshr_b32 s60, s60, 16
    s_mul_i32 s9, s60, 7
    s_sub_u32 s61, s2, s9
    v_and_b32 v23, 31, v1
    v_mul_u32_u24 v23, 36, v23
    v_lshrrev_b32 v19, 5, v1
    v_mul_u32_u24 v22, 0x480, v19
    v_add_u32 v22, v22, v23
    global_load_dwordx4 v[30:33], v22, s[16:17]
    global_load_dwordx4 v[34:37], v22, s[16:17] offset:16
    global_load_dword v38, v22, s[16:17] offset:32
    global_load_dwordx4 v[40:43], v23, s[36:37]
    global_load_dwordx4 v[44:47], v23, s[36:37] offset:16
    global_load_dword v48, v23, s[36:37] offset:32
    v_mul_u32_u24 v20, 2368, v19
    v_lshl_add_u32 v20, v23, 1, v20
    s_mov_b32 s52, s28
    s_mov_b32 s53, s29
    s_mov_b32 s54, 0x510000
    s_mov_b32 s55, 0x20000
    s_cmp_lt_u32 s60, 36
    s_cselect_b32 s10, 0, 0x80000000
    v_lshlrev_b32 v17, 4, v3
    v_or_b32 v17, s10, v17
    v_mul_u32_u24 v18, 46080, v2
    v_add_u32 v18, v18, v17
    v_mul_u32_u24 v19, 9216, v2
    v_add_u32 v19, v19, v17
    s_cmp_eq_u32 s3, 0
    s_cselect_b32 s10, 0, 0x80000000
    v_or_b32 v19, s10, v19
    s_mul_i32 s11, s61, 84
    v_mul_u32_u24 v25, 2368, v16
    v_lshl_add_u32 v25, s11, 2, v25
    v_add_u32 v25, 960, v25
    v_lshl_add_u32 v27, v2, 2, v25
    v_mad_u32_u24 v25, v2, 20, v25
    s_mul_i32 s9, s3, 80
    v_add_u32 v25, s9, v25
    s_mul_i32 s9, s3, 20
    s_add_u32 s9, s9, s11
    s_mul_i32 s9, s9, 9216
    s_min_u32 s10, s60, 35
    s_lshl_b32 s10, s10, 8
    s_add_u32 s9, s9, s10
    v_add_u32 v19, 737280, v19
    buffer_load_dwordx4 v[140:143], v19, s[52:55], s9 offen nt
    buffer_load_dwordx4 v[120:123], v18, s[52:55], s9 offen nt
    v_add_u32 v18, 9216, v18
    buffer_load_dwordx4 v[124:127], v18, s[52:55], s9 offen nt
    v_add_u32 v18, 9216, v18
    buffer_load_dwordx4 v[128:131], v18, s[52:55], s9 offen nt
    v_add_u32 v18, 9216, v18
    buffer_load_dwordx4 v[132:135], v18, s[52:55], s9 offen nt
    v_add_u32 v18, 9216, v18
    buffer_load_dwordx4 v[136:139], v18, s[52:55], s9 offen nt
    s_mov_b32 s68, s42
    s_mov_b32 s69, s43
    s_mov_b32 s70, 0x1e8080
    s_mov_b32 s71, 0x20000
    v_and_b32 v17, 1, v1
    v_lshlrev_b32 v17, 4, v17
    v_mov_b32 v18, 0xffff
    v_lshlrev_b32 v17, v17, v18
    s_mov_b32 s94, 0x3030303
    s_mov_b32 s95, 0x3030303
    v_cndmask_b32 v4, 0, v17, s[94:95]
    s_mov_b32 s94, 0xc0c0c0c
    s_mov_b32 s95, 0xc0c0c0c
    v_cndmask_b32 v5, 0, v17, s[94:95]
    s_mov_b32 s94, 0x30303030
    s_mov_b32 s95, 0x30303030
    v_cndmask_b32 v6, 0, v17, s[94:95]
    s_mov_b32 s94, 0xc0c0c0c0
    s_mov_b32 s95, 0xc0c0c0c0
    v_cndmask_b32 v7, 0, v17, s[94:95]
    v_mov_b32 v29, 0xfffff000
    s_mov_b32 s90, 0xffff0000
    s_mov_b32 s92, 0xff00ff00
    s_mov_b32 s93, 0xff00ff00
    s_mov_b32 s88, 0x01000100
    s_mov_b32 s89, 0x03020302
    s_getreg_b32 s83, hwreg(HW_REG_XCC_ID, 0, 4)
    v_mov_b32 v56, 0
    v_mov_b32 v57, 1
    v_lshrrev_b32 v17, 5, v0
    v_lshlrev_b32 v17, 9, v17
    v_lshl_add_u32 v17, v3, 5, v17
    v_and_b32 v18, 16, v1
    v_add_u32 v54, v18, v17
    v_lshlrev_b32 v55, 4, v1
    s_waitcnt lgkmcnt(0)
    s_add_u32 s86, s86, 1
    s_add_u32 s87, s87, 0x9e3779b9
    s_and_b32 s72, s86, 0xfff
    s_and_b32 s73, s87, 0xfff
    s_bfe_u32 s74, s87, 0xc000c
    s_lshr_b32 s75, s87, 20
    s_waitcnt vmcnt(17)
    v_lshrrev_b32 v52, v18, v52
    v_perm_b32 v17, v50, v50, s88
    v_and_b32 v8, v17, v4
    v_and_b32 v9, v17, v5
    v_and_b32 v10, v17, v6
    v_and_b32 v11, v17, v7
    s_waitcnt vmcnt(16)
    s_nop 0
    v_mfma_f32_16x16x32_bf16 v[72:75], v[8:11], v[76:79], 0
    v_perm_b32 v17, v50, v50, s89
    v_and_b32 v12, v17, v4
    v_and_b32 v13, v17, v5
    v_and_b32 v14, v17, v6
    v_and_b32 v15, v17, v7
    s_waitcnt vmcnt(15)
    s_nop 0
    v_mfma_f32_16x16x32_bf16 v[72:75], v[12:15], v[80:83], v[72:75]
    v_perm_b32 v17, v51, v51, s88
    v_and_b32 v8, v17, v4
    v_and_b32 v9, v17, v5
    v_and_b32 v10, v17, v6
    v_and_b32 v11, v17, v7
    s_waitcnt vmcnt(14)
    s_nop 0
    v_mfma_f32_16x16x32_bf16 v[72:75], v[8:11], v[84:87], v[72:75]
    v_perm_b32 v17, v51, v51, s89
    v_and_b32 v12, v17, v4
    v_and_b32 v13, v17, v5
    v_and_b32 v14, v17, v6
    v_and_b32 v15, v17, v7
    s_waitcnt vmcnt(13)
    s_nop 0
    v_mfma_f32_16x16x32_bf16 v[72:75], v[12:15], v[88:91], v[72:75]
    v_perm_b32 v17, v52, v52, s88
    v_and_b32 v8, v17, v4
    v_and_b32 v9, v17, v5
    v_and_b32 v10, v17, v6
    v_and_b32 v11, v17, v7
    s_waitcnt vmcnt(12)
    s_nop 0
    v_mfma_f32_16x16x32_bf16 v[72:75], v[8:11], v[92:95], v[72:75]
    s_nop 7
    ds_write_b128 v54, v[72:75] offset:14912
    s_mov_b64 exec, 1
    ds_add_rtn_u32 v17, v56, v57 offset:152
    s_mov_b64 exec, -1
    s_waitcnt lgkmcnt(0)
    v_readfirstlane_b32 s10, v17
    s_nop 1
    s_cmp_lg_u32 s10, 3
    s_cbranch_scc1 L_q1
    ds_read_b128 v[100:103], v55 offset:14912
    ds_read_b128 v[104:107], v55 offset:15936
    ds_read_b128 v[108:111], v55 offset:16960
    ds_read_b128 v[112:115], v55 offset:17984
    s_waitcnt lgkmcnt(0)
    v_pk_add_f32 v[100:101], v[100:101], v[104:105]
    v_pk_add_f32 v[102:103], v[102:103], v[106:107]
    v_pk_add_f32 v[108:109], v[108:109], v[112:113]
    v_pk_add_f32 v[110:111], v[110:111], v[114:115]
    v_pk_add_f32 v[100:101], v[100:101], v[108:109]
    v_pk_add_f32 v[102:103], v[102:103], v[110:111]
    v_add_u32 v100, 0x800, v100
    v_add_u32 v101, 0x800, v101
    v_add_u32 v102, 0x800, v102
    v_add_u32 v103, 0x800, v103
    v_and_or_b32 v100, v100, v29, s72
    v_and_or_b32 v101, v101, v29, s73
    v_and_or_b32 v102, v102, v29, s74
    v_and_or_b32 v103, v103, v29, s75
    v_xor_b32 v103, s83, v103
    s_lshl_b32 s9, s62, 10
    s_add_u32 s9, s9, 0x120000
    buffer_store_dwordx4 v[100:103], v55, s[68:71], s9 offen sc1
L_q1:
    v_lshlrev_b32 v18, 2, v3
    ds_write_b32 v18, v56 offset:3264
    ds_write_b32 v18, v56 offset:5632
    s_waitcnt vmcnt(6)
    v_mov_b32 v22, 0
    v_mov_b32 v21, 0
    v_lshlrev_b32 v100, 16, v30
    v_and_b32 v101, s90, v30
    v_lshlrev_b32 v23, 16, v40
    v_and_b32 v24, s90, v40
    v_fmac_f32 v22, v100, v23
    v_add_f32 v21, v21, v100
    v_fmac_f32 v22, v101, v24
    v_add_f32 v21, v21, v101
    v_lshlrev_b32 v102, 16, v31
    v_and_b32 v103, s90, v31
    v_lshlrev_b32 v23, 16, v41
    v_and_b32 v24, s90, v41
    v_fmac_f32 v22, v102, v23
    v_add_f32 v21, v21, v102
    v_fmac_f32 v22, v103, v24
    v_add_f32 v21, v21, v103
    v_lshlrev_b32 v104, 16, v32
    v_and_b32 v105, s90, v32
    v_lshlrev_b32 v23, 16, v42
    v_and_b32 v24, s90, v42
    v_fmac_f32 v22, v104, v23
    v_add_f32 v21, v21, v104
    v_fmac_f32 v22, v105, v24
    v_add_f32 v21, v21, v105
    v_lshlrev_b32 v106, 16, v33
    v_and_b32 v107, s90, v33
    v_lshlrev_b32 v23, 16, v43
    v_and_b32 v24, s90, v43
    v_fmac_f32 v22, v106, v23
    v_add_f32 v21, v21, v106
    v_fmac_f32 v22, v107, v24
    v_add_f32 v21, v21, v107
    v_lshlrev_b32 v108, 16, v34
    v_and_b32 v109, s90, v34
    v_lshlrev_b32 v23, 16, v44
    v_and_b32 v24, s90, v44
    v_fmac_f32 v22, v108, v23
    v_add_f32 v21, v21, v108
    v_fmac_f32 v22, v109, v24
    v_add_f32 v21, v21, v109
    v_lshlrev_b32 v110, 16, v35
    v_and_b32 v111, s90, v35
    v_lshlrev_b32 v23, 16, v45
    v_and_b32 v24, s90, v45
    v_fmac_f32 v22, v110, v23
    v_add_f32 v21, v21, v110
    v_fmac_f32 v22, v111, v24
    v_add_f32 v21, v21, v111
    v_lshlrev_b32 v112, 16, v36
    v_and_b32 v113, s90, v36
    v_lshlrev_b32 v23, 16, v46
    v_and_b32 v24, s90, v46
    v_fmac_f32 v22, v112, v23
    v_add_f32 v21, v21, v112
    v_fmac_f32 v22, v113, v24
    v_add_f32 v21, v21, v113
    v_lshlrev_b32 v114, 16, v37
    v_and_b32 v115, s90, v37
    v_lshlrev_b32 v23, 16, v47
    v_and_b32 v24, s90, v47
    v_fmac_f32 v22, v114, v23
    v_add_f32 v21, v21, v114
    v_fmac_f32 v22, v115, v24
    v_add_f32 v21, v21, v115
    v_lshlrev_b32 v116, 16, v38
    v_and_b32 v117, s90, v38
    v_lshlrev_b32 v23, 16, v48
    v_and_b32 v24, s90, v48
    v_fmac_f32 v22, v116, v23
    v_add_f32 v21, v21, v116
    v_fmac_f32 v22, v117, v24
    v_add_f32 v21, v21, v117
    s_nop 0
    v_add_f32_dpp v22, v22, v22 quad_perm:[1,0,3,2] row_mask:0xf bank_mask:0xf
    v_add_f32_dpp v21, v21, v21 quad_perm:[1,0,3,2] row_mask:0xf bank_mask:0xf
    s_nop 0
    v_add_f32_dpp v22, v22, v22 quad_perm:[2,3,0,1] row_mask:0xf bank_mask:0xf
    v_add_f32_dpp v21, v21, v21 quad_perm:[2,3,0,1] row_mask:0xf bank_mask:0xf
    s_nop 0
    v_add_f32_dpp v22, v22, v22 row_ror:4 row_mask:0xf bank_mask:0xf
    v_add_f32_dpp v21, v21, v21 row_ror:4 row_mask:0xf bank_mask:0xf
    s_nop 0
    v_add_f32_dpp v22, v22, v22 row_ror:8 row_mask:0xf bank_mask:0xf
    v_add_f32_dpp v21, v21, v21 row_ror:8 row_mask:0xf bank_mask:0xf
    v_mov_b32 v23, v22
    v_mov_b32 v24, v21
    s_nop 0
    v_permlane16_swap_b32 v22, v23
    v_permlane16_swap_b32 v21, v24
    v_add_f32 v22, v22, v23
    v_add_f32 v21, v21, v24
    v_mul_f32 v22, 0xbfb8aa3b, v22
    v_exp_f32 v22, v22
    v_mul_f32 v21, 0x3ae38e39, v21
    v_add_f32 v22, 1.0, v22
    v_rcp_f32 v22, v22
    v_mov_b32 v17, 0
    v_sub_f32 v26, 1.0, v22
    v_readlane_b32 s84, v22, 0
    v_readlane_b32 s85, v22, 32
    v_lshrrev_b32 v23, 5, v1
    v_lshlrev_b32 v23, 2, v23
    ds_write_b32 v23, v22 offset:768
    v_sub_f32 v100, v100, v21
    v_fmac_f32 v17, v100, v100
    v_sub_f32 v101, v101, v21
    v_fmac_f32 v17, v101, v101
    v_sub_f32 v102, v102, v21
    v_fmac_f32 v17, v102, v102
    v_sub_f32 v103, v103, v21
    v_fmac_f32 v17, v103, v103
    v_sub_f32 v104, v104, v21
    v_fmac_f32 v17, v104, v104
    v_sub_f32 v105, v105, v21
    v_fmac_f32 v17, v105, v105
    v_sub_f32 v106, v106, v21
    v_fmac_f32 v17, v106, v106
    v_sub_f32 v107, v107, v21
    v_fmac_f32 v17, v107, v107
    v_sub_f32 v108, v108, v21
    v_fmac_f32 v17, v108, v108
    v_sub_f32 v109, v109, v21
    v_fmac_f32 v17, v109, v109
    v_sub_f32 v110, v110, v21
    v_fmac_f32 v17, v110, v110
    v_sub_f32 v111, v111, v21
    v_fmac_f32 v17, v111, v111
    v_sub_f32 v112, v112, v21
    v_fmac_f32 v17, v112, v112
    v_sub_f32 v113, v113, v21
    v_fmac_f32 v17, v113, v113
    v_sub_f32 v114, v114, v21
    v_fmac_f32 v17, v114, v114
    v_sub_f32 v115, v115, v21
    v_fmac_f32 v17, v115, v115
    v_sub_f32 v116, v116, v21
    v_fmac_f32 v17, v116, v116
    v_sub_f32 v117, v117, v21
    v_fmac_f32 v17, v117, v117
    s_nop 1
    v_add_f32_dpp v17, v17, v17 quad_perm:[1,0,3,2] row_mask:0xf bank_mask:0xf
    s_nop 1
    v_add_f32_dpp v17, v17, v17 quad_perm:[2,3,0,1] row_mask:0xf bank_mask:0xf
    s_nop 1
    v_add_f32_dpp v17, v17, v17 row_ror:4 row_mask:0xf bank_mask:0xf
    s_nop 1
    v_add_f32_dpp v17, v17, v17 row_ror:8 row_mask:0xf bank_mask:0xf
    v_mov_b32 v23, v17
    s_nop 1
    v_permlane16_swap_b32 v17, v23
    v_add_f32 v17, v17, v23
    v_mov_b32 v23, 0x3727c5ac
    v_fmac_f32 v23, 0x3ae38e39, v17
    v_rsq_f32 v17, v23
    s_nop 0
    v_mul_f32 v100, v100, v17
    v_mul_f32 v101, v101, v17
    v_mul_f32 v102, v102, v17
    v_mul_f32 v103, v103, v17
    v_mul_f32 v104, v104, v17
    v_mul_f32 v105, v105, v17
    v_mul_f32 v106, v106, v17
    v_mul_f32 v107, v107, v17
    v_mul_f32 v108, v108, v17
    v_mul_f32 v109, v109, v17
    v_mul_f32 v110, v110, v17
    v_mul_f32 v111, v111, v17
    v_mul_f32 v112, v112, v17
    v_mul_f32 v113, v113, v17
    v_mul_f32 v114, v114, v17
    v_mul_f32 v115, v115, v17
    v_mul_f32 v116, v116, v17
    v_mul_f32 v117, v117, v17
    v_cvt_pk_bf16_f32 v100, v100, v100
    v_cvt_pk_bf16_f32 v101, v101, v101
    v_cvt_pk_bf16_f32 v102, v102, v102
    v_cvt_pk_bf16_f32 v103, v103, v103
    v_cvt_pk_bf16_f32 v104, v104, v104
    v_cvt_pk_bf16_f32 v105, v105, v105
    v_cvt_pk_bf16_f32 v106, v106, v106
    v_cvt_pk_bf16_f32 v107, v107, v107
    v_cvt_pk_bf16_f32 v108, v108, v108
    v_cvt_pk_bf16_f32 v109, v109, v109
    v_cvt_pk_bf16_f32 v110, v110, v110
    v_cvt_pk_bf16_f32 v111, v111, v111
    v_cvt_pk_bf16_f32 v112, v112, v112
    v_cvt_pk_bf16_f32 v113, v113, v113
    v_cvt_pk_bf16_f32 v114, v114, v114
    v_cvt_pk_bf16_f32 v115, v115, v115
    v_cvt_pk_bf16_f32 v116, v116, v116
    v_cvt_pk_bf16_f32 v117, v117, v117
    ds_write_b64 v20, v[100:101] offset:960
    ds_write_b64 v20, v[102:103] offset:968
    ds_write_b64 v20, v[104:105] offset:976
    ds_write_b64 v20, v[106:107] offset:984
    ds_write_b64 v20, v[108:109] offset:992
    ds_write_b64 v20, v[110:111] offset:1000
    ds_write_b64 v20, v[112:113] offset:1008
    ds_write_b64 v20, v[114:115] offset:1016
    ds_write_b64 v20, v[116:117] offset:1024
    ds_read2_b32 v[30:31], v25 offset0:0 offset1:1
    ds_read2_b32 v[32:33], v25 offset0:2 offset1:3
    ds_read_b32 v34, v25 offset:16
    ds_read_b32 v35, v27 offset:320
    s_waitcnt lgkmcnt(0)
    s_waitcnt vmcnt(0)
    v_and_b32 v8, v30, v4
    v_and_b32 v9, v30, v5
    v_and_b32 v10, v30, v6
    v_and_b32 v11, v30, v7
    s_nop 1
    v_mfma_f32_16x16x32_bf16 v[72:75], v[8:11], v[120:123], 0
    v_and_b32 v12, v31, v4
    v_and_b32 v13, v31, v5
    v_and_b32 v14, v31, v6
    v_and_b32 v15, v31, v7
    s_nop 1
    v_mfma_f32_16x16x32_bf16 v[72:75], v[12:15], v[124:127], v[72:75]
    v_and_b32 v8, v32, v4
    v_and_b32 v9, v32, v5
    v_and_b32 v10, v32, v6
    v_and_b32 v11, v32, v7
    s_nop 1
    v_mfma_f32_16x16x32_bf16 v[72:75], v[8:11], v[128:131], v[72:75]
    v_and_b32 v12, v33, v4
    v_and_b32 v13, v33, v5
    v_and_b32 v14, v33, v6
    v_and_b32 v15, v33, v7
    s_nop 1
    v_mfma_f32_16x16x32_bf16 v[72:75], v[12:15], v[132:135], v[72:75]
    v_and_b32 v8, v34, v4
    v_and_b32 v9, v34, v5
    v_and_b32 v10, v34, v6
    v_and_b32 v11, v34, v7
    s_nop 1
    v_mfma_f32_16x16x32_bf16 v[72:75], v[8:11], v[136:139], v[72:75]
    v_and_b32 v12, v35, v4
    v_and_b32 v13, v35, v5
    v_and_b32 v14, v35, v6
    v_and_b32 v15, v35, v7
    s_nop 1
    v_mfma_f32_16x16x32_bf16 v[72:75], v[12:15], v[140:143], v[72:75]
    s_nop 7
    ds_write_b128 v54, v[72:75] offset:19008
    s_mov_b64 exec, 1
    ds_add_rtn_u32 v17, v56, v57 offset:156
    s_mov_b64 exec, -1
    s_waitcnt lgkmcnt(0)
    v_readfirstlane_b32 s10, v17
    s_nop 1
    s_cmp_lg_u32 s10, 3
    s_cbranch_scc1 L_h1
    ds_read_b128 v[100:103], v55 offset:19008
    ds_read_b128 v[104:107], v55 offset:20032
    ds_read_b128 v[108:111], v55 offset:21056
    ds_read_b128 v[112:115], v55 offset:22080
    s_waitcnt lgkmcnt(0)
    v_pk_add_f32 v[100:101], v[100:101], v[104:105]
    v_pk_add_f32 v[102:103], v[102:103], v[106:107]
    v_pk_add_f32 v[108:109], v[108:109], v[112:113]
    v_pk_add_f32 v[110:111], v[110:111], v[114:115]
    v_pk_add_f32 v[100:101], v[100:101], v[108:109]
    v_pk_add_f32 v[102:103], v[102:103], v[110:111]
    v_add_u32 v100, 0x800, v100
    v_add_u32 v101, 0x800, v101
    v_add_u32 v102, 0x800, v102
    v_add_u32 v103, 0x800, v103
    v_and_or_b32 v100, v100, v29, s72
    v_and_or_b32 v101, v101, v29, s73
    v_and_or_b32 v102, v102, v29, s74
    v_and_or_b32 v103, v103, v29, s75
    s_lshl_b32 s9, s2, 10
    s_add_u32 s9, s9, 0x160000
    buffer_store_dwordx4 v[100:103], v55, s[68:71], s9 offen sc1
L_h1:
    v_mov_b32 v18, 0
    s_mov_b32 s13, 0x40000
    s_branch L_fp_go
L_fp_spin:
    s_sleep 2
L_fp_go:
    ds_read_b32 v17, v18 offset:136
    s_waitcnt lgkmcnt(0)
L_fp_chk:
    v_cmp_gt_u32 vcc, 8, v17
    s_sub_u32 s13, s13, 1
    s_cbranch_scc1 L_fp_ok
    s_cbranch_vccnz L_fp_spin
L_fp_ok:
    s_lshl_b32 s88, s6, 10
    s_lshl_b32 s89, s3, 11
    s_add_u32 s88, s88, s89
    s_add_u32 s88, s88, 0x120000
    s_mov_b32 s13, 0x40000
    s_branch L_q_go
L_q_spin:
    s_sleep 16
L_q_go:
    buffer_load_dwordx4 v[76:79], v55, s[68:71], s88 offen offset:0 sc1
    buffer_load_dwordx4 v[80:83], v55, s[68:71], s88 offen offset:1024 sc1
    s_waitcnt vmcnt(0)
L_q_chk:
    v_xor_b32 v19, s75, v79
    v_and_b32 v19, 15, v19
    v_xor_b32 v79, v79, v19
    v_xor_b32 v20, s75, v83
    v_and_b32 v20, 15, v20
    v_xor_b32 v83, v83, v20
    v_xor_b32 v76, s72, v76
    v_xor_b32 v77, s73, v77
    v_xor_b32 v78, s74, v78
    v_xor_b32 v79, s75, v79
    v_xor_b32 v80, s72, v80
    v_xor_b32 v81, s73, v81
    v_xor_b32 v82, s74, v82
    v_xor_b32 v83, s75, v83
    v_or3_b32 v17, v76, v77, v78
    v_or3_b32 v17, v17, v79, v80
    v_or3_b32 v17, v17, v81, v82
    v_or_b32 v17, v17, v83
    v_and_b32 v17, 0xfff, v17
    v_cmp_ne_u32 vcc, 0, v17
    s_sub_u32 s13, s13, 1
    s_cbranch_scc1 L_q_ok
    s_cbranch_vccnz L_q_spin
L_q_ok:
    v_xor_b32 v19, s83, v19
    v_xor_b32 v20, s83, v20
    v_or_b32 v19, v19, v20
    ds_or_b32 v56, v19 offset:164
    v_pk_add_f32 v[76:77], v[76:77], v[80:81]
    v_pk_add_f32 v[78:79], v[78:79], v[82:83]
    v_lshlrev_b32 v18, 4, v0
    ds_write_b128 v18, v[76:79] offset:23104
    s_mov_b64 exec, 1
    ds_add_rtn_u32 v17, v56, v57 offset:160
    s_mov_b64 exec, -1
    s_waitcnt lgkmcnt(0)
    v_readfirstlane_b32 s10, v17
    s_nop 1
    s_cmp_lg_u32 s10, 3
    s_cbranch_scc1 L_q2
    ds_read_b128 v[100:103], v55 offset:23104
    ds_read_b128 v[104:107], v55 offset:24128
    ds_read_b128 v[108:111], v55 offset:25152
    ds_read_b128 v[112:115], v55 offset:26176
    s_waitcnt lgkmcnt(0)
    v_pk_add_f32 v[100:101], v[100:101], v[104:105]
    v_pk_add_f32 v[102:103], v[102:103], v[106:107]
    v_pk_add_f32 v[108:109], v[108:109], v[112:113]
    v_pk_add_f32 v[110:111], v[110:111], v[114:115]
    v_pk_add_f32 v[100:101], v[100:101], v[108:109]
    v_pk_add_f32 v[102:103], v[102:103], v[110:111]
    v_cvt_pk_bf16_f32 v100, v100, v101
    v_cvt_pk_bf16_f32 v101, v102, v103
    v_lshlrev_b32 v18, 3, v1
    ds_write_b64 v18, v[100:101] offset:256
    ds_write_b32 v56, v57 offset:128
L_q2:
L_mid:
    s_lshl_b32 s63, s61, 4
    s_min_u32 s9, s61, 4
    s_lshl_b32 s9, s9, 2
    s_add_u32 s63, s63, s9
    v_and_b32 v17, 1, v2
    v_lshlrev_b32 v17, 3, v17
    v_lshl_add_u32 v25, v3, 4, v17
    s_mov_b32 s96, s34
    s_mov_b32 s97, s35
    s_mov_b32 s98, 0x480
    s_mov_b32 s99, 0x20000
    s_mov_b32 s76, s30
    s_mov_b32 s77, s31
    s_mov_b32 s78, 0x2400
    s_mov_b32 s79, 0x20000
    s_mov_b32 s56, s24
    s_mov_b32 s57, s25
    s_mov_b32 s58, 0x480000
    s_mov_b32 s59, 0x20000
    s_mov_b32 s64, s32
    s_mov_b32 s65, s33
    s_mov_b32 s66, 0x510000
    s_mov_b32 s67, 0x20000
    s_lshl_b32 s10, s3, 8
    s_cmp_eq_u32 s2, 0
    s_cselect_b32 s10, s10, 0x80000000
    v_add_u32 v46, s10, v25
    s_min_u32 s11, s60, 35
    s_lshl_b32 s88, s11, 7
    s_add_u32 s88, s88, s63
    s_lshl_b32 s15, s88, 1
    v_lshlrev_b32 v22, 3, v2
    v_lshlrev_b32 v23, 1, v2
    v_and_b32 v19, 7, v1
    v_min_u32 v19, 6, v19
    v_lshlrev_b32 v19, 10, v19
    v_lshl_add_u32 v19, v16, 9, v19
    v_lshl_add_u32 v20, v2, 4, v19
    s_mul_i32 s14, s11, 7168
    s_lshl_b32 s11, s63, 2
    s_add_u32 s14, s14, s11
    s_add_u32 s14, s14, 0x160000
    s_cmp_lt_u32 s61, 4
    s_cselect_b32 s7, 64, 0
    s_add_u32 s7, s7, s14
    v_mov_b32 v47, s84
    v_mov_b32 v18, s85
    v_cndmask_b32 v47, v47, v18, s[92:93]
    v_sub_f32 v47, 1.0, v47
    v_mul_u32_u24 v32, 0x1200, v2
    v_lshl_add_u32 v32, v3, 4, v32
    s_cmp_lt_u32 s60, 36
    s_cselect_b32 s9, 0, 0x80000000
    v_or_b32 v30, s9, v32
    s_cmp_lt_u32 s61, 4
    s_cselect_b32 s9, s9, 0x80000000
    v_mul_u32_u24 v31, 0x480, v2
    v_lshl_add_u32 v31, v3, 4, v31
    v_or_b32 v31, s9, v31
    v_lshrrev_b32 v18, 5, v1
    v_mul_u32_u24 v18, 0x900, v18
    v_lshl_add_u32 v44, v25, 1, v18
    v_cmp_gt_u32 vcc, 8, v3
    v_mov_b32 v28, 0x80000000
    s_nop 0
    v_cndmask_b32 v33, v28, v30, vcc
    v_cndmask_b32 v34, v28, v31, vcc
    v_cndmask_b32 v35, v28, v32, vcc
    v_cndmask_b32 v45, v28, v44, vcc
    s_lshl_b32 s10, s3, 8
    s_mul_i32 s88, s88, 0x480
    s_add_u32 s88, s88, s10
    s_cmp_lt_u32 s61, 4
    s_cselect_b32 s89, 18432, 0
    s_add_u32 s89, s89, s88
    s_mul_i32 s100, s62, 18432
    s_add_u32 s100, s100, s10
    s_mul_i32 s101, s2, 4608
    s_lshl_b32 s10, s3, 9
    s_add_u32 s101, s101, s10
    buffer_load_dwordx2 v[144:145], v46, s[96:99], 0 offen
    buffer_load_dwordx2 v[146:147], v46, s[96:99], 0 offen offset:256
    buffer_load_dwordx2 v[148:149], v22, s[76:79], s15 offen
    buffer_load_ushort v150, v23, s[76:79], s15 offen offset:32
    buffer_load_dwordx4 v[152:155], v20, s[68:71], s14 offen sc1
    buffer_load_dwordx4 v[156:159], v19, s[68:71], s7 offen sc1
    s_waitcnt vmcnt(0)
    s_mov_b32 s13, 0x40000
    s_branch L_h_chk
L_h_spin:
    s_sleep 40
L_h_go:
    buffer_load_dwordx4 v[152:155], v20, s[68:71], s14 offen sc1
    buffer_load_dwordx4 v[156:159], v19, s[68:71], s7 offen sc1
    s_waitcnt vmcnt(0)
L_h_chk:
    v_xor_b32 v152, s72, v152
    v_xor_b32 v153, s73, v153
    v_xor_b32 v154, s74, v154
    v_xor_b32 v155, s75, v155
    v_xor_b32 v156, s72, v156
    v_xor_b32 v157, s73, v157
    v_xor_b32 v158, s74, v158
    v_xor_b32 v159, s75, v159
    v_or3_b32 v17, v152, v153, v154
    v_or3_b32 v17, v17, v155, v156
    v_or3_b32 v17, v17, v157, v158
    v_or_b32 v17, v17, v159
    v_and_b32 v17, 0xfff, v17
    v_cmp_ne_u32 vcc, 0, v17
    s_sub_u32 s13, s13, 1
    s_cbranch_scc1 L_h_ok
    s_cbranch_vccnz L_h_spin
L_h_ok:
    v_cmp_eq_u32 vcc, 1, v2
    s_nop 1
    v_cndmask_b32 v156, v156, v157, vcc
    v_cmp_eq_u32 vcc, 2, v2
    s_nop 1
    v_cndmask_b32 v156, v156, v158, vcc
    v_cmp_eq_u32 vcc, 3, v2
    s_nop 1
    v_cndmask_b32 v156, v156, v159, vcc
    s_mov_b32 s94, 0x7f7f7f7f
    s_mov_b32 s95, 0x7f7f7f7f
    v_cndmask_b32 v152, 0, v152, s[94:95]
    v_cndmask_b32 v153, 0, v153, s[94:95]
    v_cndmask_b32 v154, 0, v154, s[94:95]
    v_cndmask_b32 v155, 0, v155, s[94:95]
    v_cndmask_b32 v156, 0, v156, s[94:95]
    v_add_f32_dpp v152, v152, v152 quad_perm:[1,0,3,2] row_mask:0xf bank_mask:0xf
    v_add_f32_dpp v153, v153, v153 quad_perm:[1,0,3,2] row_mask:0xf bank_mask:0xf
    v_add_f32_dpp v154, v154, v154 quad_perm:[1,0,3,2] row_mask:0xf bank_mask:0xf
    v_add_f32_dpp v155, v155, v155 quad_perm:[1,0,3,2] row_mask:0xf bank_mask:0xf
    v_add_f32_dpp v156, v156, v156 quad_perm:[1,0,3,2] row_mask:0xf bank_mask:0xf
    v_add_f32_dpp v152, v152, v152 quad_perm:[2,3,0,1] row_mask:0xf bank_mask:0xf
    v_add_f32_dpp v153, v153, v153 quad_perm:[2,3,0,1] row_mask:0xf bank_mask:0xf
    v_add_f32_dpp v154, v154, v154 quad_perm:[2,3,0,1] row_mask:0xf bank_mask:0xf
    v_add_f32_dpp v155, v155, v155 quad_perm:[2,3,0,1] row_mask:0xf bank_mask:0xf
    v_add_f32_dpp v156, v156, v156 quad_perm:[2,3,0,1] row_mask:0xf bank_mask:0xf
    v_add_f32_dpp v152, v152, v152 row_half_mirror row_mask:0xf bank_mask:0xf
    v_add_f32_dpp v153, v153, v153 row_half_mirror row_mask:0xf bank_mask:0xf
    v_add_f32_dpp v154, v154, v154 row_half_mirror row_mask:0xf bank_mask:0xf
    v_add_f32_dpp v155, v155, v155 row_half_mirror row_mask:0xf bank_mask:0xf
    v_add_f32_dpp v156, v156, v156 row_half_mirror row_mask:0xf bank_mask:0xf
    v_lshlrev_b32 v160, 16, v148
    v_add_f32 v152, v152, v160
    v_and_b32 v161, s90, v148
    v_add_f32 v153, v153, v161
    v_lshlrev_b32 v162, 16, v149
    v_add_f32 v154, v154, v162
    v_and_b32 v163, s90, v149
    v_add_f32 v155, v155, v163
    v_lshlrev_b32 v164, 16, v150
    v_add_f32 v156, v156, v164
    v_mul_f32 v160, v152, v152
    v_mul_f32 v161, v153, v153
    v_mul_f32 v162, v154, v154
    v_mul_f32 v163, v155, v155
    v_mul_f32 v164, v156, v156
    v_mul_f32 v160, 0x3d372713, v160
    v_mul_f32 v161, 0x3d372713, v161
    v_mul_f32 v162, 0x3d372713, v162
    v_mul_f32 v163, 0x3d372713, v163
    v_mul_f32 v164, 0x3d372713, v164
    v_add_f32 v160, 1.0, v160
    v_add_f32 v161, 1.0, v161
    v_add_f32 v162, 1.0, v162
    v_add_f32 v163, 1.0, v163
    v_add_f32 v164, 1.0, v164
    v_mul_f32 v160, v160, v152
    v_mul_f32 v161, v161, v153
    v_mul_f32 v162, v162, v154
    v_mul_f32 v163, v163, v155
    v_mul_f32 v164, v164, v156
    v_mul_f32 v160, 0xc0135761, v160
    v_mul_f32 v161, 0xc0135761, v161
    v_mul_f32 v162, 0xc0135761, v162
    v_mul_f32 v163, 0xc0135761, v163
    v_mul_f32 v164, 0xc0135761, v164
    v_exp_f32 v160, v160
    v_exp_f32 v161, v161
    v_exp_f32 v162, v162
    v_exp_f32 v163, v163
    v_exp_f32 v164, v164
    v_add_f32 v160, 1.0, v160
    v_add_f32 v161, 1.0, v161
    v_add_f32 v162, 1.0, v162
    v_add_f32 v163, 1.0, v163
    v_add_f32 v164, 1.0, v164
    v_rcp_f32 v160, v160
    v_rcp_f32 v161, v161
    v_rcp_f32 v162, v162
    v_rcp_f32 v163, v163
    v_rcp_f32 v164, v164
    v_mul_f32 v152, v152, v47
    v_mul_f32 v153, v153, v47
    v_mul_f32 v154, v154, v47
    v_mul_f32 v155, v155, v47
    v_mul_f32 v156, v156, v47
    v_mul_f32 v152, v152, v160
    v_mul_f32 v153, v153, v161
    v_mul_f32 v154, v154, v162
    v_mul_f32 v155, v155, v163
    v_mul_f32 v156, v156, v164
    v_cvt_pk_bf16_f32 v152, v152, v152
    v_cvt_pk_bf16_f32 v153, v153, v153
    v_cvt_pk_bf16_f32 v154, v154, v154
    v_cvt_pk_bf16_f32 v155, v155, v155
    v_cvt_pk_bf16_f32 v156, v156, v156
    s_cmp_lt_u32 s60, 36
    s_cselect_b32 s9, -1, 0
    s_cmp_lt_u32 s61, 4
    s_cselect_b32 s10, s9, 0
    v_and_b32 v152, s9, v152
    v_and_b32 v153, s9, v153
    v_and_b32 v154, s9, v154
    v_and_b32 v155, s9, v155
    v_and_b32 v156, s10, v156
    v_and_b32 v48, v152, v4
    v_and_b32 v49, v152, v5
    v_and_b32 v50, v152, v6
    v_and_b32 v51, v152, v7
    v_and_b32 v52, v153, v4
    v_and_b32 v53, v153, v5
    v_and_b32 v54, v153, v6
    v_and_b32 v55, v153, v7
    v_and_b32 v56, v154, v4
    v_and_b32 v57, v154, v5
    v_and_b32 v58, v154, v6
    v_and_b32 v59, v154, v7
    v_and_b32 v60, v155, v4
    v_and_b32 v61, v155, v5
    v_and_b32 v62, v155, v6
    v_and_b32 v63, v155, v7
    v_and_b32 v64, v156, v4
    v_and_b32 v65, v156, v5
    v_and_b32 v66, v156, v6
    v_and_b32 v67, v156, v7
    v_lshlrev_b32 v36, 16, v144
    v_mul_f32 v36, v36, v26
    v_and_b32 v37, s90, v144
    v_mul_f32 v37, v37, v26
    v_lshlrev_b32 v38, 16, v145
    v_mul_f32 v38, v38, v26
    v_and_b32 v39, s90, v145
    v_mul_f32 v39, v39, v26
    v_lshlrev_b32 v40, 16, v146
    v_mul_f32 v40, v40, v26
    v_and_b32 v41, s90, v146
    v_mul_f32 v41, v41, v26
    v_lshlrev_b32 v42, 16, v147
    v_mul_f32 v42, v42, v26
    v_and_b32 v43, s90, v147
    v_mul_f32 v43, v43, v26
    s_cmp_lg_u32 s3, 3
    s_cbranch_scc1 L_now
    buffer_load_dwordx4 v[108:111], v33, s[64:67], s88 offen offset:256 nt
    buffer_load_dwordx4 v[112:115], v33, s[64:67], s88 offen offset:1408 nt
    buffer_load_dwordx4 v[116:119], v33, s[64:67], s88 offen offset:2560 nt
    buffer_load_dwordx4 v[120:123], v33, s[64:67], s88 offen offset:3712 nt
    buffer_load_dwordx4 v[124:127], v34, s[64:67], s89 offen offset:256 nt
    buffer_load_dwordx4 v[128:131], v35, s[56:59], s100 offen offset:256 nt
    buffer_load_dwordx4 v[132:135], v35, s[56:59], s100 offen offset:1408 nt
    buffer_load_dwordx4 v[136:139], v35, s[56:59], s100 offen offset:2560 nt
    buffer_load_dwordx4 v[140:143], v35, s[56:59], s100 offen offset:3712 nt
    s_waitcnt vmcnt(0)
    v_mfma_f32_16x16x32_bf16 v[40:43], v[48:51], v[108:111], v[40:43]
    v_mfma_f32_16x16x32_bf16 v[40:43], v[52:55], v[112:115], v[40:43]
    v_mfma_f32_16x16x32_bf16 v[40:43], v[56:59], v[116:119], v[40:43]
    v_mfma_f32_16x16x32_bf16 v[40:43], v[60:63], v[120:123], v[40:43]
    v_mfma_f32_16x16x32_bf16 v[40:43], v[64:67], v[124:127], v[40:43]
L_now:
    v_lshrrev_b32 v18, 3, v1
    v_lshlrev_b32 v18, 4, v18
    v_mov_b32 v21, 0
    s_mov_b32 s13, 0x40000
    s_branch L_fd_go
L_fd_spin:
    s_sleep 2
L_fd_go:
    ds_read_b32 v17, v21 offset:132
    s_waitcnt lgkmcnt(0)
L_fd_chk:
    v_cmp_gt_u32 vcc, 8, v17
    s_sub_u32 s13, s13, 1
    s_cbranch_scc1 L_fd_ok
    s_cbranch_vccnz L_fd_spin
L_fd_ok:
    buffer_load_dwordx4 v[72:75], v30, s[64:67], s88 offen offset:0 nt
    buffer_load_dwordx4 v[76:79], v30, s[64:67], s88 offen offset:1152 nt
    buffer_load_dwordx4 v[80:83], v30, s[64:67], s88 offen offset:2304 nt
    buffer_load_dwordx4 v[84:87], v30, s[64:67], s88 offen offset:3456 nt
    v_mov_b32 v21, 0
    s_mov_b32 s13, 0x40000
    s_branch L_fw_go
L_fw_spin:
    s_sleep 1
L_fw_go:
    ds_read_b32 v17, v21 offset:144
    s_waitcnt lgkmcnt(0)
L_fw_chk:
    v_cmp_gt_u32 vcc, 1, v17
    s_sub_u32 s13, s13, 1
    s_cbranch_scc1 L_fw_ok
    s_cbranch_vccnz L_fw_spin
L_fw_ok:
    buffer_load_dwordx4 v[88:91], v31, s[64:67], s89 offen offset:0 nt
    buffer_load_dwordx4 v[92:95], v32, s[56:59], s100 offen offset:0 nt
    buffer_load_dwordx4 v[96:99], v32, s[56:59], s100 offen offset:1152 nt
    buffer_load_dwordx4 v[100:103], v32, s[56:59], s100 offen offset:2304 nt
    buffer_load_dwordx4 v[104:107], v32, s[56:59], s100 offen offset:3456 nt
    s_waitcnt vmcnt(5)
    v_mfma_f32_16x16x32_bf16 v[36:39], v[48:51], v[72:75], v[36:39]
    v_mfma_f32_16x16x32_bf16 v[36:39], v[52:55], v[76:79], v[36:39]
    v_mfma_f32_16x16x32_bf16 v[36:39], v[56:59], v[80:83], v[36:39]
    v_mfma_f32_16x16x32_bf16 v[36:39], v[60:63], v[84:87], v[36:39]
    s_mov_b32 s13, 0x40000
L_u_spin:
L_u_go:
    ds_read_b32 v17, v21 offset:148
    ds_read_b128 v[148:151], v18 offset:832
    s_waitcnt lgkmcnt(0)
L_u_chk:
    v_cmp_eq_u32 vcc, 0, v17
    s_sub_u32 s13, s13, 1
    s_cbranch_scc1 L_u_ok
    s_cbranch_vccnz L_u_spin
L_u_ok:
    v_and_b32 v152, v148, v4
    v_and_b32 v153, v148, v5
    v_and_b32 v154, v148, v6
    v_and_b32 v155, v148, v7
    v_and_b32 v156, v149, v4
    v_and_b32 v157, v149, v5
    v_and_b32 v158, v149, v6
    v_and_b32 v159, v149, v7
    v_and_b32 v160, v150, v4
    v_and_b32 v161, v150, v5
    v_and_b32 v162, v150, v6
    v_and_b32 v163, v150, v7
    v_and_b32 v164, v151, v4
    v_and_b32 v165, v151, v5
    v_and_b32 v166, v151, v6
    v_and_b32 v167, v151, v7
    s_cmp_lg_u32 s3, 3
    s_cbranch_scc1 L_now3
    v_mfma_f32_16x16x32_bf16 v[40:43], v[152:155], v[128:131], v[40:43]
    v_mfma_f32_16x16x32_bf16 v[40:43], v[156:159], v[132:135], v[40:43]
    v_mfma_f32_16x16x32_bf16 v[40:43], v[160:163], v[136:139], v[40:43]
    v_mfma_f32_16x16x32_bf16 v[40:43], v[164:167], v[140:143], v[40:43]
L_now3:
    s_waitcnt vmcnt(4)
    v_mfma_f32_16x16x32_bf16 v[36:39], v[64:67], v[88:91], v[36:39]
    s_waitcnt vmcnt(3)
    v_mfma_f32_16x16x32_bf16 v[36:39], v[152:155], v[92:95], v[36:39]
    s_waitcnt vmcnt(2)
    v_mfma_f32_16x16x32_bf16 v[36:39], v[156:159], v[96:99], v[36:39]
    s_waitcnt vmcnt(1)
    v_mfma_f32_16x16x32_bf16 v[36:39], v[160:163], v[100:103], v[36:39]
    s_waitcnt vmcnt(0)
    v_mfma_f32_16x16x32_bf16 v[36:39], v[164:167], v[104:107], v[36:39]
    s_cmp_lg_u32 s3, 3
    s_cbranch_scc1 L_now4
    s_nop 3
    v_add_u32 v40, 0x800, v40
    v_add_u32 v41, 0x800, v41
    v_add_u32 v42, 0x800, v42
    v_add_u32 v43, 0x800, v43
    v_and_or_b32 v40, v40, v29, s72
    v_and_or_b32 v41, v41, v29, s73
    v_and_or_b32 v42, v42, v29, s74
    v_and_or_b32 v43, v43, v29, s75
    buffer_store_dwordx4 v[40:43], v45, s[68:71], s101 offen offset:512 sc1
L_now4:
    s_nop 5
    v_add_u32 v36, 0x800, v36
    v_add_u32 v37, 0x800, v37
    v_add_u32 v38, 0x800, v38
    v_add_u32 v39, 0x800, v39
    v_and_or_b32 v36, v36, v29, s72
    v_and_or_b32 v37, v37, v29, s73
    v_and_or_b32 v38, v38, v29, s74
    v_and_or_b32 v39, v39, v29, s75
    buffer_store_dwordx4 v[36:39], v44, s[68:71], s101 offen sc1
    v_mov_b32 v17, 0
    v_mov_b32 v18, 1
    s_mov_b64 exec, 1
    ds_add_u32 v17, v18 offset:148
    s_mov_b64 exec, -1
L_end:
    s_endpgm
.section .rodata,"a"
.p2align 6
.amdhsa_kernel gated_mix__mha_block_cached__mixer_channel_mlp__decode_kernel
  .amdhsa_next_free_vgpr 168
  .amdhsa_next_free_sgpr 102
  .amdhsa_accum_offset 168
  .amdhsa_group_segment_fixed_size 0
  .amdhsa_kernarg_size 112
  .amdhsa_user_sgpr_count 2
  .amdhsa_user_sgpr_kernarg_segment_ptr 1
  .amdhsa_system_sgpr_workgroup_id_x 1
  .amdhsa_float_denorm_mode_32 3
.end_amdhsa_kernel
```
